```python
import torch

def _softmax(x, axis=-1):
    return torch.softmax(x, dim=axis)
def _gelu(x):
    return torch.nn.functional.gelu(x, approximate="tanh")
def _silu(x):
    return torch.nn.functional.silu(x)
def _sigmoid(x):
    return torch.sigmoid(x)
def _layernorm(x, axis=-1, eps=1e-5):
    m = x.mean(dim=axis, keepdim=True)
    v = x.var(dim=axis, keepdim=True, unbiased=False)
    return (x - m) / torch.sqrt(v + eps)
def _scatter_add(tgt, idx, src, axis=0):
    return tgt.clone().index_add_(axis, idx, src)
def _segment_sum(src, seg, n):
    out = torch.zeros((n,) + src.shape[1:], dtype=src.dtype)
    return out.index_add_(0, seg, src)
def _pad(x, pw):
    flat = tuple(v for pair in reversed(pw) for v in pair)
    return torch.nn.functional.pad(x, flat)

kernel_name = 'gated_mix__ssm_conv_s4__glu_gated_bilinear__prompt'

def setup_inputs():

    _w = (lambda a: (lambda t: t.to(torch.bfloat16) if t.is_floating_point() else t)(torch.as_tensor(a)))
    def _A_setup():
        B, L, D, N = 1, 2048, 512, 128
        A_re = -(lambda _x: torch.exp(torch.as_tensor(_x)))((lambda *s: torch.randn(*s, dtype=torch.bfloat16) * 3.2)(D, N))
        A_im = torch.pi * (lambda *s: torch.randn(*s, dtype=torch.bfloat16) * 0.05)(D, N)
        B_re = (lambda *s: torch.randn(*s, dtype=torch.bfloat16) * 0.1)(D, N)
        B_im = (lambda *s: torch.randn(*s, dtype=torch.bfloat16) * 0.1)(D, N)
        C_re = (lambda *s: torch.randn(*s, dtype=torch.bfloat16) * 0.1)(D, N)
        C_im = (lambda *s: torch.randn(*s, dtype=torch.bfloat16) * 0.1)(D, N)
        log_dt = (lambda *s: torch.randn(*s, dtype=torch.bfloat16) * 0.05)(D) * 0.5 - 4.0
        Dskip = (lambda *s: torch.randn(*s, dtype=torch.bfloat16) * 0.05)(D)
        return {
            "u": _w((lambda *s: torch.randn(*s, dtype=torch.bfloat16) * 0.05)(B, L, D)),
            "A_re": _w(A_re),
            "A_im": _w(A_im),
            "B_re": _w(B_re),
            "B_im": _w(B_im),
            "C_re": _w(C_re),
            "C_im": _w(C_im),
            "log_dt": _w(log_dt),
            "Dskip": _w(Dskip),
        }
    _A_in = _A_setup()

    def _B_setup():
        B, S, D, F = 1, 2048, 512, 1792
        return {
            "x": _w((lambda *s: torch.randn(*s, dtype=torch.bfloat16) * 0.05)(B, S, D)),
            "w_gate": _w((lambda *s: torch.randn(*s, dtype=torch.bfloat16) * 0.8)(D, F) * (D ** -0.5)),
            "w_up": _w((lambda *s: torch.randn(*s, dtype=torch.bfloat16) * 0.8)(D, F) * (D ** -0.5)),
            "w_down": _w((lambda *s: torch.randn(*s, dtype=torch.bfloat16) * 0.8)(F, D) * (F ** -0.5)),
        }
    _B_in = _B_setup()

    return {
        "A_u": _A_in["u"],
        "A_A_re": _A_in["A_re"],
        "A_A_im": _A_in["A_im"],
        "A_B_re": _A_in["B_re"],
        "A_B_im": _A_in["B_im"],
        "A_C_re": _A_in["C_re"],
        "A_C_im": _A_in["C_im"],
        "A_log_dt": _A_in["log_dt"],
        "A_Dskip": _A_in["Dskip"],
        "B_x": _B_in["x"],
        "B_w_gate": _B_in["w_gate"],
        "B_w_up": _B_in["w_up"],
        "B_w_down": _B_in["w_down"],
        "gate_w": _w((lambda *s: torch.randn(*s, dtype=torch.bfloat16) * 0.05)(512) * 16.0),
    }

def reference(A_u, A_A_re, A_A_im, A_B_re, A_B_im, A_C_re, A_C_im, A_log_dt, A_Dskip, B_x, B_w_gate, B_w_up, B_w_down, gate_w):
    def _A_ref(u, A_re, A_im, B_re, B_im, C_re, C_im, log_dt, Dskip):
        Bsz, L, D = u.shape
        dt = torch.exp(log_dt)[:, None]
        A = A_re + 1j * A_im
        Bc = B_re + 1j * B_im
        Cc = C_re + 1j * C_im
        logdA = dt * A
        dB = dt * Bc
        l = (lambda x, dt: x.to(dt))(torch.arange(L), A_re.dtype)
        P = torch.exp(logdA[:, :, None] * l[None, None, :])
        K = torch.einsum("dn,dnl,dn->dl", Cc, P, dB).real
        L2 = 2 * L
        Kp = _pad(K, ((0, 0), (0, L)))
        up = (lambda x, *d: x.permute(*d))(u, 0, 2, 1)
        up = _pad(up, ((0, 0), (0, 0), (0, L)))
        Kf = (lambda x, axes=(-2,-1): torch.fft.rfft2(x.float(), dim=axes))(Kp[:, None, :], axes=(-2, -1))
        Uf = (lambda x, axes=(-2,-1): torch.fft.rfft2(x.float(), dim=axes))(up[:, :, None, :], axes=(-2, -1))
        Yf = Uf * Kf[None, :, :, :]
        y = (lambda x, s, axes=(-2,-1): torch.fft.irfft2(x, s=s, dim=axes).to(torch.bfloat16))(Yf, (1, L2), axes=(-2, -1))[:, :, 0, :L]
        y = (lambda x, *d: x.permute(*d))(y, 0, 2, 1) + u * Dskip[None, None, :]
        return y

    def _B_ref(x, w_gate, w_up, w_down):
        g = torch.einsum("bsd,df->bsf", x, w_gate)
        u = torch.einsum("bsd,df->bsf", x, w_up)
        h = g * u
        return torch.einsum("bsf,fd->bsd", h, w_down)

    x = A_u
    g = _sigmoid((x * gate_w).sum(-1, keepdims=True))
    a = _A_ref(x, A_A_re, A_A_im, A_B_re, A_B_im, A_C_re, A_C_im, A_log_dt, A_Dskip)
    b = _B_ref(x, B_w_gate, B_w_up, B_w_down)
    return g * a + (1 - g) * b
```

```asm
; @launch grid=(256,1,1) block=(512,1,1) lds=163840
.amdgcn_target "amdgcn-amd-amdhsa--gfx950"
.text
.globl gated_mix__ssm_conv_s4__glu_gated_bilinear__prompt_kernel
.p2align 8
.type gated_mix__ssm_conv_s4__glu_gated_bilinear__prompt_kernel,@function
gated_mix__ssm_conv_s4__glu_gated_bilinear__prompt_kernel:
    s_cmp_ge_u32 s2, 256
    s_cbranch_scc1 L_end
    s_load_dwordx16 s[16:31], s[0:1], 0
    s_load_dwordx16 s[32:47], s[0:1], 64
    s_load_dwordx2 s[48:49], s[0:1], 128
    v_lshrrev_b32 v2, 6, v0
    s_lshr_b32 s5, s2, 3
    s_getpc_b64 s[10:11]
L_pc:
    s_lshl_b32 s12, s5, 10
    v_lshl_add_u32 v3, v2, 7, s12
    v_and_b32 v4, 1, v0
    v_lshl_add_u32 v3, v4, 6, v3
    v_and_b32 v4, 2, v0
    v_lshl_add_u32 v3, v4, 14, v3
    v_min_u32 v3, L_end-L_pc, v3
    global_load_dword v19, v3, s[10:11]
    v_and_b32 v1, 63, v0
    v_readfirstlane_b32 s3, v2
    s_and_b32 s4, s2, 7
    s_lshr_b32 s10, s3, 2
    s_lshl_b32 s11, s2, 1
    s_add_u32 s11, s11, s10
    s_and_b32 s12, s3, 1
    s_lshl_b32 s13, s11, 8
    s_lshl_b32 s12, s12, 7
    s_add_u32 s13, s13, s12
    v_lshl_add_u32 v168, v1, 1, s13
    s_lshl_b32 s11, s11, 1
    v_mov_b32 v169, s11
    v_mov_b32 v160, 0
    v_mov_b32 v161, 0
    v_mov_b32 v162, 0
    v_mov_b32 v163, 0
    v_mov_b32 v164, 0
    v_mov_b32 v165, 0
    v_mov_b32 v166, 0
    s_bitcmp1_b32 s3, 1
    s_cselect_b64 s[14:15], -1, 0
    s_and_b32 s10, s4, 6
    s_lshl_b32 s6, s10, 1
    s_and_b32 s7, s5, 3
    s_add_u32 s6, s6, s7
    s_and_b32 s10, s4, 6
    s_lshl_b32 s87, s10, 7
    s_mul_i32 s10, s10, 0x11111111
    s_add_u32 s99, s10, 0x76543210
    s_lshl_b32 s10, s6, 7
    s_lshl_b32 s11, s3, 4
    s_add_u32 s10, s10, s11
    s_lshl_b32 s10, s10, 10
    v_lshrrev_b32 v14, 3, v1
    v_lshlrev_b32 v14, 10, v14
    v_lshrrev_b32 v15, 4, v1
    v_and_b32 v16, 7, v1
    v_xor_b32 v16, v16, v15
    v_lshl_add_u32 v14, v16, 4, v14
    v_add_u32 v4, s10, v14
    v_xor_b32 v5, 64, v4
    v_add_u32 v5, 0x2000, v5
    s_lshl_b32 s86, s3, 11
    s_mov_b32 s54, 0x200000
    s_mov_b32 s55, 0x20000
    s_waitcnt lgkmcnt(0)
    global_load_short_d16_hi v166, v169, s[30:31]
    global_load_short_d16_hi v160, v168, s[18:19] nt
    global_load_short_d16_hi v161, v168, s[20:21] nt
    global_load_short_d16_hi v162, v168, s[22:23] nt
    global_load_short_d16_hi v163, v168, s[24:25] nt
    global_load_short_d16_hi v164, v168, s[26:27] nt
    global_load_short_d16_hi v165, v168, s[28:29] nt
    s_mov_b32 s52, s16
    s_and_b32 s53, s17, 0xffff
    s_cmp_lt_u32 s5, 4
    s_cselect_b32 s77, 1, 0
    s_cbranch_scc1 L_aux
    s_add_u32 m0, s86, 0
    s_nop 0
    buffer_load_dwordx4 v4, s[52:55], s87 offen lds
    s_add_u32 m0, s86, 1024
    s_nop 0
    buffer_load_dwordx4 v5, s[52:55], s87 offen lds
    s_mov_b32 s0, s99
    s_and_b32 s7, s4, 1
    s_mul_i32 s7, s7, 7
    s_lshr_b32 s8, s5, 2
    s_add_u32 s7, s7, s8
    s_sub_u32 s7, s7, 1
    s_and_b32 s12, s3, 3
    s_mul_i32 s10, s12, 14336
    s_lshl_b32 s11, s7, 8
    s_add_u32 s10, s10, s11
    v_mul_u32_u24 v14, 3584, v15
    s_and_b32 s11, s3, 2
    s_lshl_b32 s11, s11, 2
    v_lshl_or_b32 v16, v15, 1, s11
    v_and_b32 v17, 15, v1
    v_xor_b32 v16, v16, v17
    v_lshl_add_u32 v14, v16, 4, v14
    v_add_u32 v6, s10, v14
    s_cmp_ge_u32 s3, 4
    s_cselect_b32 s56, s38, s36
    s_cselect_b32 s57, s39, s37
    s_cselect_b32 s10, 16384, 0
    s_and_b32 s57, s57, 0xffff
    s_mov_b32 s58, 0x1c0000
    s_mov_b32 s59, 0x20000
    s_lshl_b32 s12, s12, 10
    s_add_u32 s10, s10, s12
    s_and_b32 s11, s5, 3
    s_mul_i32 s60, s11, 57344
    s_lshl_b32 s11, s11, 12
    s_add_u32 s20, s10, s11
    s_bfe_u32 s87, s0, 0x30000
    s_mul_i32 s1, s87, 229376
    s_lshl_b32 s87, s87, 7
    s_add_u32 m0, s20, 98304
    s_add_u32 s24, s1, s60
    buffer_load_dwordx4 v6, s[56:59], s24 offen lds
    s_bfe_u32 s87, s0, 0x30004
    s_mul_i32 s1, s87, 229376
    s_lshl_b32 s87, s87, 7
    s_add_u32 m0, s20, 131072
    s_add_u32 s24, s1, s60
    buffer_load_dwordx4 v6, s[56:59], s24 offen lds
    s_add_u32 s11, s5, 1
    s_and_b32 s11, s11, 3
    s_mul_i32 s61, s11, 57344
    s_lshl_b32 s11, s11, 12
    s_add_u32 s21, s10, s11
    s_add_u32 s11, s5, 2
    s_and_b32 s11, s11, 3
    s_mul_i32 s62, s11, 57344
    s_lshl_b32 s11, s11, 12
    s_add_u32 s22, s10, s11
    s_add_u32 s11, s5, 3
    s_and_b32 s11, s11, 3
    s_mul_i32 s63, s11, 57344
    s_lshl_b32 s11, s11, 12
    s_add_u32 s23, s10, s11
    s_and_b32 s8, s3, 1
    s_lshr_b32 s9, s3, 1
    s_mov_b32 s78, 0
    v_mov_b32 v235, 0
    v_mov_b32 v252, 0
    s_mov_b32 s66, 0xe00000
    s_mov_b32 s67, 0x20000
    s_mov_b32 s70, 0x1c0000
    s_mov_b32 s71, 0x20000
    s_mov_b32 s74, 0x200000
    s_mov_b32 s75, 0x20000
    s_lshr_b32 s10, s3, 1
    s_mul_i32 s10, s10, 16368
    s_and_b32 s11, s3, 1
    s_lshl_b32 s11, s11, 8
    s_add_u32 s88, s10, s11
    s_and_b32 s10, s3, 3
    s_mul_i32 s10, s10, 16368
    s_add_u32 s10, s10, 32768
    v_bfe_u32 v15, v1, 4, 1
    v_lshlrev_b32 v15, 8, v15
    v_lshrrev_b32 v16, 5, v1
    v_lshl_add_u32 v15, v16, 7, v15
    v_and_b32 v14, 15, v1
    v_mul_u32_u24 v16, 528, v14
    v_add3_u32 v153, v16, v15, s10
    s_bitcmp1_b32 s3, 2
    s_mov_b32 s11, 0x42006420
    s_cmov_b32 s11, 0x55315531
    s_mov_b32 s12, 0xeca88644
    s_cmov_b32 s12, 0xdb97db97
    s_mov_b32 s13, 0xff0
    s_cmov_b32 s13, 0xf0f0
    v_cmp_lt_u32 vcc, 7, v14
    v_mov_b32 v152, s11
    v_mov_b32 v16, s12
    v_cndmask_b32 v152, v152, v16, vcc
    v_and_b32 v16, 7, v1
    v_lshlrev_b32 v16, 2, v16
    v_bfe_u32 v152, v152, v16, 4
    v_bfe_u32 v16, s13, v14, 1
    v_mad_u32_u24 v152, v16, 31, v152
    v_mul_u32_u24 v152, 528, v152
    s_bfe_u32 s10, s3, 0x10001
    s_mul_i32 s11, s10, 32736
    s_add_u32 s11, s11, 41216
    v_add3_u32 v152, v152, v15, s11
    s_mul_i32 s10, s10, 4160
    s_and_b32 s11, s3, 1
    s_lshl_b32 s11, s11, 8
    s_add_u32 s10, s10, s11
    s_add_u32 s10, s10, 49216
    s_bitcmp1_b32 s3, 2
    s_mov_b32 s11, 0x1414000
    s_cmov_b32 s11, 0xc0804000
    s_cselect_b32 s12, 1024, 0
    s_add_u32 s10, s10, s12
    v_lshrrev_b32 v15, 4, v1
    v_lshlrev_b32 v15, 3, v15
    v_bfe_u32 v15, s11, v15, 8
    v_lshlrev_b32 v14, 4, v14
    v_lshl_add_u32 v14, v15, 3, v14
    v_add_u32 v154, s10, v14
    s_add_u32 m0, s86, 16384
    s_nop 0
    buffer_load_dwordx4 v4, s[52:55], s87 offen lds
    s_add_u32 m0, s86, 17408
    s_nop 0
    buffer_load_dwordx4 v5, s[52:55], s87 offen lds
    s_cmp_eq_u32 s3, 0
    s_cbranch_scc1 L_st0
    s_cmp_eq_u32 s3, 2
    s_cbranch_scc1 L_st2
L_stret:
    s_waitcnt vmcnt(6)
    v_mul_f32 v167, 0x3fb8aa3b, v166
    v_mov_b32 v169, 0x3fb8aa3b
    v_fma_f32 v168, v166, v169, -v167
    v_fmac_f32 v168, 0x32a57060, v166
    v_exp_f32 v167, v167
    v_mul_f32 v168, 0x3f317218, v168
    v_fmac_f32 v167, v167, v168
    v_cvt_pk_bf16_f32 v167, v167, v167
    v_and_b32 v167, 0xffff0000, v167
    v_mul_f32 v160, v167, v160
    v_mul_f32 v161, v167, v161
    v_mul_f32 v162, v167, v162
    v_mul_f32 v163, v167, v163
    v_mul_f32 v160, 0x3fb8aa3b, v160
    v_mul_f32 v161, 0.15915494, v161
    v_mul_f32 v169, 0x43000000, v160
    v_exp_f32 v167, v160
    v_mul_f32 v166, 0x43000000, v161
    v_fract_f32 v168, v161
    v_exp_f32 v169, v169
    v_cos_f32 v172, v168
    v_fract_f32 v166, v166
    v_sin_f32 v173, v168
    v_cos_f32 v180, v166
    v_mul_f32 v172, v167, v172
    v_sin_f32 v181, v166
    v_mul_f32 v173, v167, v173
    v_mul_f32 v180, v169, v180
    v_pk_mul_f32 v[170:171], v[164:165], v[162:163] op_sel_hi:[1,0]
    v_mul_f32 v181, v169, v181
    v_pk_fma_f32 v[170:171], v[164:165], v[162:163], v[170:171] op_sel:[1,1,0] op_sel_hi:[0,1,1] neg_lo:[1,0,0]
    v_pk_mul_f32 v[174:175], v[172:173], v[172:173] op_sel_hi:[1,0]
    v_pk_mul_f32 v[182:183], v[180:181], v[180:181] op_sel_hi:[1,0]
    v_pk_fma_f32 v[174:175], v[172:173], v[172:173], v[174:175] op_sel:[1,1,0] op_sel_hi:[0,1,1] neg_lo:[1,0,0]
    v_pk_fma_f32 v[182:183], v[180:181], v[180:181], v[182:183] op_sel:[1,1,0] op_sel_hi:[0,1,1] neg_lo:[1,0,0]
    v_pk_mul_f32 v[176:177], v[174:175], v[174:175] op_sel_hi:[1,0]
    v_pk_mul_f32 v[184:185], v[182:183], v[182:183] op_sel_hi:[1,0]
    v_pk_fma_f32 v[176:177], v[174:175], v[174:175], v[176:177] op_sel:[1,1,0] op_sel_hi:[0,1,1] neg_lo:[1,0,0]
    v_pk_fma_f32 v[184:185], v[182:183], v[182:183], v[184:185] op_sel:[1,1,0] op_sel_hi:[0,1,1] neg_lo:[1,0,0]
    v_pk_mul_f32 v[178:179], v[176:177], v[176:177] op_sel_hi:[1,0]
    v_pk_fma_f32 v[178:179], v[176:177], v[176:177], v[178:179] op_sel:[1,1,0] op_sel_hi:[0,1,1] neg_lo:[1,0,0]
    v_cndmask_b32 v186, v172, v174, s[14:15]
    v_cndmask_b32 v187, v173, v175, s[14:15]
    v_cndmask_b32 v188, 1.0, v180, s[14:15]
    v_cndmask_b32 v189, 0, v181, s[14:15]
    v_cndmask_b32 v182, 1.0, v182, s[14:15]
    v_cndmask_b32 v183, 0, v183, s[14:15]
    v_pk_mul_f32 v[196:197], v[170:171], v[182:183] op_sel_hi:[1,0]
    v_pk_fma_f32 v[196:197], v[170:171], v[182:183], v[196:197] op_sel:[1,1,0] op_sel_hi:[0,1,1] neg_lo:[1,0,0]
    s_mov_b32 m0, s88
    v_cvt_pk_bf16_f32 v204, v188, v189
    v_cvt_pk_bf16_f32 v220, v196, -v197
    v_pk_mul_f32 v[190:191], v[188:189], v[178:179] op_sel_hi:[1,0]
    ds_write_addtid_b32 v204 offset:32768
    v_pk_mul_f32 v[192:193], v[196:197], v[186:187] op_sel_hi:[1,0]
    v_pk_fma_f32 v[190:191], v[188:189], v[178:179], v[190:191] op_sel:[1,1,0] op_sel_hi:[0,1,1] neg_lo:[1,0,0]
    v_pk_fma_f32 v[192:193], v[196:197], v[186:187], v[192:193] op_sel:[1,1,0] op_sel_hi:[0,1,1] neg_lo:[1,0,0]
    v_cvt_pk_bf16_f32 v205, v190, v191
    v_cvt_pk_bf16_f32 v222, v192, -v193
    ds_write_addtid_b32 v220 offset:41216
    v_pk_mul_f32 v[188:189], v[190:191], v[178:179] op_sel_hi:[1,0]
    ds_write_addtid_b32 v205 offset:33296
    v_pk_mul_f32 v[194:195], v[192:193], v[186:187] op_sel_hi:[1,0]
    v_pk_fma_f32 v[188:189], v[190:191], v[178:179], v[188:189] op_sel:[1,1,0] op_sel_hi:[0,1,1] neg_lo:[1,0,0]
    v_pk_fma_f32 v[194:195], v[192:193], v[186:187], v[194:195] op_sel:[1,1,0] op_sel_hi:[0,1,1] neg_lo:[1,0,0]
    v_cvt_pk_bf16_f32 v206, v188, v189
    v_cvt_pk_bf16_f32 v224, v194, -v195
    ds_write_addtid_b32 v222 offset:42272
    v_pk_mul_f32 v[190:191], v[188:189], v[178:179] op_sel_hi:[1,0]
    ds_write_addtid_b32 v206 offset:33824
    v_pk_mul_f32 v[192:193], v[194:195], v[186:187] op_sel_hi:[1,0]
    v_pk_fma_f32 v[190:191], v[188:189], v[178:179], v[190:191] op_sel:[1,1,0] op_sel_hi:[0,1,1] neg_lo:[1,0,0]
    v_pk_fma_f32 v[192:193], v[194:195], v[186:187], v[192:193] op_sel:[1,1,0] op_sel_hi:[0,1,1] neg_lo:[1,0,0]
    v_cvt_pk_bf16_f32 v207, v190, v191
    v_cvt_pk_bf16_f32 v226, v192, -v193
    ds_write_addtid_b32 v224 offset:43328
    v_pk_mul_f32 v[188:189], v[190:191], v[178:179] op_sel_hi:[1,0]
    ds_write_addtid_b32 v207 offset:34352
    v_pk_mul_f32 v[194:195], v[192:193], v[186:187] op_sel_hi:[1,0]
    v_pk_fma_f32 v[188:189], v[190:191], v[178:179], v[188:189] op_sel:[1,1,0] op_sel_hi:[0,1,1] neg_lo:[1,0,0]
    v_pk_fma_f32 v[194:195], v[192:193], v[186:187], v[194:195] op_sel:[1,1,0] op_sel_hi:[0,1,1] neg_lo:[1,0,0]
    v_cvt_pk_bf16_f32 v208, v188, v189
    v_cvt_pk_bf16_f32 v228, v194, -v195
    ds_write_addtid_b32 v226 offset:44384
    v_pk_mul_f32 v[190:191], v[188:189], v[178:179] op_sel_hi:[1,0]
    ds_write_addtid_b32 v208 offset:34880
    v_pk_mul_f32 v[192:193], v[194:195], v[186:187] op_sel_hi:[1,0]
    v_pk_fma_f32 v[190:191], v[188:189], v[178:179], v[190:191] op_sel:[1,1,0] op_sel_hi:[0,1,1] neg_lo:[1,0,0]
    v_pk_fma_f32 v[192:193], v[194:195], v[186:187], v[192:193] op_sel:[1,1,0] op_sel_hi:[0,1,1] neg_lo:[1,0,0]
    v_cvt_pk_bf16_f32 v209, v190, v191
    v_cvt_pk_bf16_f32 v230, v192, -v193
    ds_write_addtid_b32 v228 offset:45440
    v_pk_mul_f32 v[188:189], v[190:191], v[178:179] op_sel_hi:[1,0]
    ds_write_addtid_b32 v209 offset:35408
    v_pk_mul_f32 v[194:195], v[192:193], v[186:187] op_sel_hi:[1,0]
    v_pk_fma_f32 v[188:189], v[190:191], v[178:179], v[188:189] op_sel:[1,1,0] op_sel_hi:[0,1,1] neg_lo:[1,0,0]
    v_pk_fma_f32 v[194:195], v[192:193], v[186:187], v[194:195] op_sel:[1,1,0] op_sel_hi:[0,1,1] neg_lo:[1,0,0]
    v_cvt_pk_bf16_f32 v210, v188, v189
    v_cvt_pk_bf16_f32 v232, v194, -v195
    ds_write_addtid_b32 v230 offset:46496
    v_pk_mul_f32 v[190:191], v[188:189], v[178:179] op_sel_hi:[1,0]
    ds_write_addtid_b32 v210 offset:35936
    v_pk_mul_f32 v[192:193], v[194:195], v[186:187] op_sel_hi:[1,0]
    v_pk_fma_f32 v[190:191], v[188:189], v[178:179], v[190:191] op_sel:[1,1,0] op_sel_hi:[0,1,1] neg_lo:[1,0,0]
    s_bfe_u32 s87, s0, 0x30000
    s_mul_i32 s1, s87, 229376
    s_lshl_b32 s87, s87, 7
    s_add_u32 m0, s21, 98304
    s_add_u32 s24, s1, s61
    buffer_load_dwordx4 v6, s[56:59], s24 offen lds
    s_mov_b32 m0, s88
    v_pk_fma_f32 v[192:193], v[194:195], v[186:187], v[192:193] op_sel:[1,1,0] op_sel_hi:[0,1,1] neg_lo:[1,0,0]
    v_cvt_pk_bf16_f32 v211, v190, v191
    v_cvt_pk_bf16_f32 v234, v192, -v193
    ds_write_addtid_b32 v232 offset:47552
    v_pk_mul_f32 v[188:189], v[190:191], v[178:179] op_sel_hi:[1,0]
    ds_write_addtid_b32 v211 offset:36464
    v_pk_mul_f32 v[198:199], v[196:197], v[184:185] op_sel_hi:[1,0]
    v_pk_fma_f32 v[188:189], v[190:191], v[178:179], v[188:189] op_sel:[1,1,0] op_sel_hi:[0,1,1] neg_lo:[1,0,0]
    v_pk_fma_f32 v[198:199], v[196:197], v[184:185], v[198:199] op_sel:[1,1,0] op_sel_hi:[0,1,1] neg_lo:[1,0,0]
    v_cvt_pk_bf16_f32 v212, v188, v189
    v_cvt_pk_bf16_f32 v221, v198, -v199
    ds_write_addtid_b32 v234 offset:48608
    v_pk_mul_f32 v[190:191], v[188:189], v[178:179] op_sel_hi:[1,0]
    ds_write_addtid_b32 v212 offset:36992
    v_pk_mul_f32 v[194:195], v[198:199], v[176:177] op_sel_hi:[1,0]
    v_pk_fma_f32 v[190:191], v[188:189], v[178:179], v[190:191] op_sel:[1,1,0] op_sel_hi:[0,1,1] neg_lo:[1,0,0]
    v_pk_fma_f32 v[194:195], v[198:199], v[176:177], v[194:195] op_sel:[1,1,0] op_sel_hi:[0,1,1] neg_lo:[1,0,0]
    v_cvt_pk_bf16_f32 v213, v190, v191
    v_cvt_pk_bf16_f32 v223, v194, -v195
    ds_write_addtid_b32 v221 offset:41744
    v_pk_mul_f32 v[188:189], v[190:191], v[178:179] op_sel_hi:[1,0]
    ds_write_addtid_b32 v213 offset:37520
    v_pk_mul_f32 v[192:193], v[198:199], v[178:179] op_sel_hi:[1,0]
    v_pk_fma_f32 v[188:189], v[190:191], v[178:179], v[188:189] op_sel:[1,1,0] op_sel_hi:[0,1,1] neg_lo:[1,0,0]
    v_pk_fma_f32 v[192:193], v[198:199], v[178:179], v[192:193] op_sel:[1,1,0] op_sel_hi:[0,1,1] neg_lo:[1,0,0]
    v_cvt_pk_bf16_f32 v214, v188, v189
    s_add_u32 m0, s22, 98304
    s_add_u32 s24, s1, s62
    buffer_load_dwordx4 v6, s[56:59], s24 offen lds
    s_mov_b32 m0, s88
    v_cvt_pk_bf16_f32 v225, v192, -v193
    ds_write_addtid_b32 v223 offset:42800
    v_pk_mul_f32 v[190:191], v[188:189], v[178:179] op_sel_hi:[1,0]
    ds_write_addtid_b32 v214 offset:38048
    v_pk_mul_f32 v[200:201], v[198:199], v[184:185] op_sel_hi:[1,0]
    v_pk_fma_f32 v[190:191], v[188:189], v[178:179], v[190:191] op_sel:[1,1,0] op_sel_hi:[0,1,1] neg_lo:[1,0,0]
    v_pk_fma_f32 v[200:201], v[198:199], v[184:185], v[200:201] op_sel:[1,1,0] op_sel_hi:[0,1,1] neg_lo:[1,0,0]
    v_cvt_pk_bf16_f32 v215, v190, v191
    v_cvt_pk_bf16_f32 v227, v200, -v201
    ds_write_addtid_b32 v225 offset:43856
    v_pk_mul_f32 v[188:189], v[190:191], v[178:179] op_sel_hi:[1,0]
    ds_write_addtid_b32 v215 offset:38576
    v_pk_mul_f32 v[194:195], v[200:201], v[178:179] op_sel_hi:[1,0]
    v_pk_fma_f32 v[188:189], v[190:191], v[178:179], v[188:189] op_sel:[1,1,0] op_sel_hi:[0,1,1] neg_lo:[1,0,0]
    v_pk_fma_f32 v[194:195], v[200:201], v[178:179], v[194:195] op_sel:[1,1,0] op_sel_hi:[0,1,1] neg_lo:[1,0,0]
    v_cvt_pk_bf16_f32 v216, v188, v189
    v_cvt_pk_bf16_f32 v229, v194, -v195
    ds_write_addtid_b32 v227 offset:44912
    v_pk_mul_f32 v[190:191], v[188:189], v[178:179] op_sel_hi:[1,0]
    ds_write_addtid_b32 v216 offset:39104
    v_pk_mul_f32 v[198:199], v[200:201], v[184:185] op_sel_hi:[1,0]
    v_pk_fma_f32 v[190:191], v[188:189], v[178:179], v[190:191] op_sel:[1,1,0] op_sel_hi:[0,1,1] neg_lo:[1,0,0]
    v_pk_fma_f32 v[198:199], v[200:201], v[184:185], v[198:199] op_sel:[1,1,0] op_sel_hi:[0,1,1] neg_lo:[1,0,0]
    v_cvt_pk_bf16_f32 v217, v190, v191
    v_cvt_pk_bf16_f32 v231, v198, -v199
    ds_write_addtid_b32 v229 offset:45968
    v_pk_mul_f32 v[188:189], v[190:191], v[178:179] op_sel_hi:[1,0]
    ds_write_addtid_b32 v217 offset:39632
    s_add_u32 m0, s23, 98304
    s_add_u32 s24, s1, s63
    buffer_load_dwordx4 v6, s[56:59], s24 offen lds
    s_mov_b32 m0, s88
    v_pk_mul_f32 v[192:193], v[198:199], v[178:179] op_sel_hi:[1,0]
    v_pk_fma_f32 v[188:189], v[190:191], v[178:179], v[188:189] op_sel:[1,1,0] op_sel_hi:[0,1,1] neg_lo:[1,0,0]
    v_pk_fma_f32 v[192:193], v[198:199], v[178:179], v[192:193] op_sel:[1,1,0] op_sel_hi:[0,1,1] neg_lo:[1,0,0]
    v_cvt_pk_bf16_f32 v218, v188, v189
    v_cvt_pk_bf16_f32 v233, v192, -v193
    ds_write_addtid_b32 v231 offset:47024
    v_pk_mul_f32 v[190:191], v[188:189], v[178:179] op_sel_hi:[1,0]
    ds_write_addtid_b32 v218 offset:40160
    v_pk_fma_f32 v[190:191], v[188:189], v[178:179], v[190:191] op_sel:[1,1,0] op_sel_hi:[0,1,1] neg_lo:[1,0,0]
    v_cvt_pk_bf16_f32 v219, v190, v191
    ds_write_addtid_b32 v233 offset:48080
    ds_write_addtid_b32 v219 offset:40688
    s_waitcnt lgkmcnt(0)
    s_barrier
    ds_read_b128 v[160:163], v152 offset:0
    ds_read_b128 v[164:167], v153 offset:0
    ds_read_b128 v[168:171], v152 offset:16
    ds_read_b128 v[172:175], v153 offset:16
    ds_read_b128 v[176:179], v152 offset:32
    ds_read_b128 v[180:183], v153 offset:32
    ds_read_b128 v[184:187], v152 offset:48
    ds_read_b128 v[188:191], v153 offset:48
    ds_read_b128 v[192:195], v152 offset:64
    ds_read_b128 v[196:199], v153 offset:64
    ds_read_b128 v[200:203], v152 offset:80
    ds_read_b128 v[204:207], v153 offset:80
    ds_read_b128 v[208:211], v152 offset:96
    ds_read_b128 v[212:215], v153 offset:96
    ds_read_b128 v[216:219], v152 offset:112
    ds_read_b128 v[220:223], v153 offset:112
    s_mov_b32 s28, s36
    s_and_b32 s29, s37, 0xffff
    s_mov_b32 s30, 0x1c0000
    s_mov_b32 s31, 0x20000
    s_bfe_u32 s87, s0, 0x30004
    s_mul_i32 s1, s87, 229376
    s_lshl_b32 s87, s87, 7
    s_add_u32 m0, s21, 131072
    s_add_u32 s24, s1, s61
    buffer_load_dwordx4 v6, s[56:59], s24 offen lds
    s_add_u32 m0, s22, 131072
    s_add_u32 s24, s1, s62
    buffer_load_dwordx4 v6, s[56:59], s24 offen lds
    s_add_u32 m0, s23, 131072
    s_add_u32 s24, s1, s63
    buffer_load_dwordx4 v6, s[56:59], s24 offen lds
    s_cmp_ge_u32 s3, 4
    s_cbranch_scc1 Lr1_1
    v_and_b32 v18, 15, v1
    v_lshrrev_b32 v19, 4, v1
    v_bfe_u32 v20, v1, 1, 3
    v_xor_b32 v20, v20, v19
    v_lshlrev_b32 v18, 7, v18
    v_lshl_add_u32 v18, v20, 4, v18
    s_lshl_b32 s10, s8, 13
    v_add_u32 v8, s10, v18
    v_xor_b32 v9, 64, v8
    v_bfe_u32 v18, v1, 2, 2
    v_lshl_add_u32 v18, v19, 3, v18
    v_lshlrev_b32 v18, 8, v18
    v_bfe_u32 v20, v1, 2, 3
    s_and_b32 s10, s3, 2
    s_lshl_b32 s10, s10, 1
    v_xor_b32 v20, s10, v20
    v_lshl_add_u32 v18, v20, 5, v18
    v_and_b32 v20, 3, v1
    v_lshl_add_u32 v18, v20, 3, v18
    v_add_u32 v10, 65536, v18
    v_xor_b32 v11, 32, v10
    v_xor_b32 v12, 64, v10
    v_xor_b32 v13, 96, v10
    v_add_u32 v14, 65536, v10
    v_add_u32 v15, 65536, v11
    v_add_u32 v16, 65536, v12
    v_add_u32 v17, 65536, v13
    s_branch Lr2_2
Lr1_1:
    v_subrev_u32 v8, 0x10000, v4
    v_subrev_u32 v9, 0x10000, v5
Lr2_2:
    s_waitcnt lgkmcnt(14)
    v_mfma_f32_16x16x32_bf16 v[236:239], v[160:163], v[164:167], 0
    s_waitcnt lgkmcnt(12)
    v_mfma_f32_16x16x32_bf16 v[236:239], v[168:171], v[172:175], v[236:239]
    s_waitcnt lgkmcnt(10)
    v_mfma_f32_16x16x32_bf16 v[236:239], v[176:179], v[180:183], v[236:239]
    s_waitcnt lgkmcnt(8)
    v_mfma_f32_16x16x32_bf16 v[236:239], v[184:187], v[188:191], v[236:239]
    s_waitcnt lgkmcnt(6)
    v_mfma_f32_16x16x32_bf16 v[236:239], v[192:195], v[196:199], v[236:239]
    s_waitcnt lgkmcnt(4)
    v_mfma_f32_16x16x32_bf16 v[236:239], v[200:203], v[204:207], v[236:239]
    s_waitcnt lgkmcnt(2)
    v_mfma_f32_16x16x32_bf16 v[236:239], v[208:211], v[212:215], v[236:239]
    s_waitcnt lgkmcnt(0)
    v_mfma_f32_16x16x32_bf16 v[236:239], v[216:219], v[220:223], v[236:239]
    s_waitcnt vmcnt(3)
    s_barrier
    s_cmp_ge_u32 s3, 4
    s_cbranch_scc1 L_load
    s_setprio 2
    ds_read_b64_tr_b16 v[52:53], v10 offset:32768
    ds_read_b64_tr_b16 v[54:55], v10 offset:33792
    ds_read_b128 v[20:23], v8 offset:0
    ds_read_b128 v[24:27], v8 offset:2048
    ds_read_b128 v[28:31], v8 offset:4096
    ds_read_b128 v[32:35], v8 offset:6144
    ds_read_b64_tr_b16 v[56:57], v10 offset:49152
    ds_read_b64_tr_b16 v[58:59], v10 offset:50176
    ds_read_b64_tr_b16 v[60:61], v11 offset:32768
    ds_read_b64_tr_b16 v[62:63], v11 offset:33792
    ds_read_b64_tr_b16 v[64:65], v11 offset:49152
    ds_read_b64_tr_b16 v[66:67], v11 offset:50176
    ds_read_b64_tr_b16 v[68:69], v12 offset:32768
    ds_read_b64_tr_b16 v[70:71], v12 offset:33792
    ds_read_b64_tr_b16 v[72:73], v12 offset:49152
    ds_read_b64_tr_b16 v[74:75], v12 offset:50176
    ds_read_b64_tr_b16 v[76:77], v13 offset:32768
    ds_read_b64_tr_b16 v[78:79], v13 offset:33792
    ds_read_b64_tr_b16 v[80:81], v13 offset:49152
    ds_read_b64_tr_b16 v[82:83], v13 offset:50176
    v_cvt_pk_bf16_f32 v160, v236, v237
    v_cvt_pk_bf16_f32 v161, v238, v239
    ds_write_b64 v154, v[160:161]
    s_waitcnt lgkmcnt(15)
    v_mfma_f32_16x16x32_bf16 v[92:95], v[52:55], v[20:23], 0
    ds_read_b64_tr_b16 v[84:85], v10 offset:40960
    v_mfma_f32_16x16x32_bf16 v[96:99], v[52:55], v[24:27], 0
    ds_read_b64_tr_b16 v[86:87], v10 offset:41984
    v_mfma_f32_16x16x32_bf16 v[100:103], v[52:55], v[28:31], 0
    ds_read_b64_tr_b16 v[88:89], v10 offset:57344
    v_mfma_f32_16x16x32_bf16 v[104:107], v[52:55], v[32:35], 0
    ds_read_b64_tr_b16 v[90:91], v10 offset:58368
    s_waitcnt lgkmcnt(15)
    v_mfma_f32_16x16x32_bf16 v[168:171], v[56:59], v[32:35], 0
    ds_read_b64_tr_b16 v[52:53], v11 offset:40960
    v_mfma_f32_16x16x32_bf16 v[164:167], v[56:59], v[28:31], 0
    ds_read_b64_tr_b16 v[54:55], v11 offset:41984
    v_mfma_f32_16x16x32_bf16 v[160:163], v[56:59], v[24:27], 0
    ds_read_b128 v[36:39], v9 offset:0
    v_mfma_f32_16x16x32_bf16 v[156:159], v[56:59], v[20:23], 0
    ds_read_b64_tr_b16 v[56:57], v11 offset:57344
    v_mfma_f32_16x16x32_bf16 v[108:111], v[60:63], v[20:23], 0
    ds_read_b64_tr_b16 v[58:59], v11 offset:58368
    v_mfma_f32_16x16x32_bf16 v[112:115], v[60:63], v[24:27], 0
    ds_read_b128 v[40:43], v9 offset:2048
    v_mfma_f32_16x16x32_bf16 v[116:119], v[60:63], v[28:31], 0
    ds_read_b128 v[44:47], v9 offset:4096
    v_mfma_f32_16x16x32_bf16 v[120:123], v[60:63], v[32:35], 0
    ds_read_b64_tr_b16 v[60:61], v12 offset:40960
    s_waitcnt lgkmcnt(15)
    v_mfma_f32_16x16x32_bf16 v[184:187], v[64:67], v[32:35], 0
    ds_read_b64_tr_b16 v[62:63], v12 offset:41984
    v_mfma_f32_16x16x32_bf16 v[180:183], v[64:67], v[28:31], 0
    ds_read_b128 v[48:51], v9 offset:6144
    v_mfma_f32_16x16x32_bf16 v[176:179], v[64:67], v[24:27], 0
    s_mov_b32 s64, s48
    s_and_b32 s65, s49, 0xffff
    v_mfma_f32_16x16x32_bf16 v[172:175], v[64:67], v[20:23], 0
    ds_read_b64_tr_b16 v[64:65], v12 offset:57344
    v_mfma_f32_16x16x32_bf16 v[124:127], v[68:71], v[20:23], 0
    ds_read_b64_tr_b16 v[66:67], v12 offset:58368
    v_mfma_f32_16x16x32_bf16 v[128:131], v[68:71], v[24:27], 0
    s_mov_b32 s68, s40
    s_and_b32 s69, s41, 0xffff
    v_mfma_f32_16x16x32_bf16 v[132:135], v[68:71], v[28:31], 0
    s_mov_b32 s72, s44
    s_and_b32 s73, s45, 0xffff
    v_mfma_f32_16x16x32_bf16 v[136:139], v[68:71], v[32:35], 0
    ds_read_b64_tr_b16 v[68:69], v13 offset:40960
    v_mfma_f32_16x16x32_bf16 v[200:203], v[72:75], v[32:35], 0
    ds_read_b64_tr_b16 v[70:71], v13 offset:41984
    v_mfma_f32_16x16x32_bf16 v[196:199], v[72:75], v[28:31], 0
    s_lshl_b32 s10, s6, 2
    s_lshl_b32 s11, s8, 1
    v_mfma_f32_16x16x32_bf16 v[192:195], v[72:75], v[24:27], 0
    s_add_u32 s10, s10, s11
    s_mul_i32 s10, s10, 112
    v_mfma_f32_16x16x32_bf16 v[188:191], v[72:75], v[20:23], 0
    ds_read_b64_tr_b16 v[72:73], v13 offset:57344
    v_mfma_f32_16x16x32_bf16 v[140:143], v[76:79], v[20:23], 0
    ds_read_b64_tr_b16 v[74:75], v13 offset:58368
    v_mfma_f32_16x16x32_bf16 v[144:147], v[76:79], v[24:27], 0
    s_lshl_b32 s11, s7, 3
    s_add_u32 s10, s10, s11
    v_mfma_f32_16x16x32_bf16 v[148:151], v[76:79], v[28:31], 0
    s_lshl_b32 s11, s9, 2
    s_add_u32 s10, s10, s11
    v_mfma_f32_16x16x32_bf16 v[152:155], v[76:79], v[32:35], 0
    s_lshl_b32 s34, s10, 10
    s_mul_i32 s10, s6, 1280
    s_waitcnt lgkmcnt(15)
    v_mfma_f32_16x16x32_bf16 v[216:219], v[80:83], v[32:35], 0
    s_lshl_b32 s11, s7, 2
    s_add_u32 s10, s10, s11
    v_mfma_f32_16x16x32_bf16 v[212:215], v[80:83], v[28:31], 0
    s_add_u32 s35, s10, 13107200
    s_and_b32 s80, s4, 6
    v_mfma_f32_16x16x32_bf16 v[208:211], v[80:83], v[24:27], 0
    s_lshl_b32 s80, s80, 2
    s_and_b32 s10, s5, 7
    v_mfma_f32_16x16x32_bf16 v[204:207], v[80:83], v[20:23], 0
    s_add_u32 s80, s80, s10
    s_and_b32 s81, s4, 1
    s_waitcnt vmcnt(0) lgkmcnt(0)
    s_barrier
    v_mfma_f32_16x16x32_bf16 v[92:95], v[84:87], v[36:39], v[92:95]
    ds_read_b64_tr_b16 v[76:77], v14 offset:0
    v_mfma_f32_16x16x32_bf16 v[96:99], v[84:87], v[40:43], v[96:99]
    ds_read_b64_tr_b16 v[78:79], v14 offset:1024
    v_mfma_f32_16x16x32_bf16 v[100:103], v[84:87], v[44:47], v[100:103]
    ds_read_b64_tr_b16 v[80:81], v14 offset:16384
    v_mfma_f32_16x16x32_bf16 v[104:107], v[84:87], v[48:51], v[104:107]
    ds_read_b64_tr_b16 v[82:83], v14 offset:17408
    v_mfma_f32_16x16x32_bf16 v[168:171], v[88:91], v[48:51], v[168:171]
    ds_read_b64_tr_b16 v[84:85], v15 offset:0
    v_mfma_f32_16x16x32_bf16 v[164:167], v[88:91], v[44:47], v[164:167]
    ds_read_b64_tr_b16 v[86:87], v15 offset:1024
    v_mfma_f32_16x16x32_bf16 v[160:163], v[88:91], v[40:43], v[160:163]
    ds_read_b128 v[20:23], v8 offset:16384
    v_mfma_f32_16x16x32_bf16 v[156:159], v[88:91], v[36:39], v[156:159]
    ds_read_b64_tr_b16 v[88:89], v15 offset:16384
    v_mfma_f32_16x16x32_bf16 v[108:111], v[52:55], v[36:39], v[108:111]
    ds_read_b64_tr_b16 v[90:91], v15 offset:17408
    v_mfma_f32_16x16x32_bf16 v[112:115], v[52:55], v[40:43], v[112:115]
    ds_read_b128 v[24:27], v8 offset:18432
    v_mfma_f32_16x16x32_bf16 v[116:119], v[52:55], v[44:47], v[116:119]
    ds_read_b128 v[28:31], v8 offset:20480
    v_mfma_f32_16x16x32_bf16 v[120:123], v[52:55], v[48:51], v[120:123]
    ds_read_b64_tr_b16 v[52:53], v16 offset:0
    v_mfma_f32_16x16x32_bf16 v[184:187], v[56:59], v[48:51], v[184:187]
    ds_read_b64_tr_b16 v[54:55], v16 offset:1024
    v_mfma_f32_16x16x32_bf16 v[180:183], v[56:59], v[44:47], v[180:183]
    ds_read_b128 v[32:35], v8 offset:22528
    v_mfma_f32_16x16x32_bf16 v[176:179], v[56:59], v[40:43], v[176:179]
    s_lshl_b32 s81, s81, 2
    s_lshr_b32 s10, s5, 3
    v_mfma_f32_16x16x32_bf16 v[172:175], v[56:59], v[36:39], v[172:175]
    ds_read_b64_tr_b16 v[56:57], v16 offset:16384
    v_mfma_f32_16x16x32_bf16 v[124:127], v[60:63], v[36:39], v[124:127]
    ds_read_b64_tr_b16 v[58:59], v16 offset:17408
    v_mfma_f32_16x16x32_bf16 v[128:131], v[60:63], v[40:43], v[128:131]
    s_add_u32 s81, s81, s10
    s_lshr_b32 s82, s3, 2
    v_mfma_f32_16x16x32_bf16 v[132:135], v[60:63], v[44:47], v[132:135]
    s_and_b32 s83, s3, 3
    s_lshl_b32 s10, s80, 1
    v_mfma_f32_16x16x32_bf16 v[136:139], v[60:63], v[48:51], v[136:139]
    ds_read_b64_tr_b16 v[60:61], v17 offset:0
    v_mfma_f32_16x16x32_bf16 v[200:203], v[64:67], v[48:51], v[200:203]
    ds_read_b64_tr_b16 v[62:63], v17 offset:1024
    v_mfma_f32_16x16x32_bf16 v[196:199], v[64:67], v[44:47], v[196:199]
    s_and_b32 s13, s3, 1
    s_add_u32 s10, s10, s13
    v_mfma_f32_16x16x32_bf16 v[192:195], v[64:67], v[40:43], v[192:195]
    s_mul_i32 s11, s10, 112
    s_lshr_b32 s12, s3, 1
    v_mfma_f32_16x16x32_bf16 v[188:191], v[64:67], v[36:39], v[188:191]
    ds_read_b64_tr_b16 v[64:65], v17 offset:16384
    v_mfma_f32_16x16x32_bf16 v[140:143], v[68:71], v[36:39], v[140:143]
    ds_read_b64_tr_b16 v[66:67], v17 offset:17408
    v_mfma_f32_16x16x32_bf16 v[144:147], v[68:71], v[40:43], v[144:147]
    s_mul_i32 s100, s12, 458752
    s_lshl_b32 s13, s13, 15
    v_mfma_f32_16x16x32_bf16 v[148:151], v[68:71], v[44:47], v[148:151]
    s_add_u32 s100, s100, s13
    s_mul_i32 s13, s12, 28
    v_mfma_f32_16x16x32_bf16 v[152:155], v[68:71], v[48:51], v[152:155]
    s_add_u32 s11, s11, s13
    s_lshl_b32 s84, s11, 10
    v_mfma_f32_16x16x32_bf16 v[216:219], v[72:75], v[48:51], v[216:219]
    s_lshl_b32 s51, s10, 7
    s_add_u32 s51, s51, 12582912
    v_mfma_f32_16x16x32_bf16 v[212:215], v[72:75], v[44:47], v[212:215]
    s_lshl_b32 s10, s10, 15
    s_lshl_b32 s11, s81, 7
    v_mfma_f32_16x16x32_bf16 v[208:211], v[72:75], v[40:43], v[208:211]
    s_lshl_b32 s12, s12, 5
    s_add_u32 s50, s11, s12
    v_mfma_f32_16x16x32_bf16 v[204:207], v[72:75], v[36:39], v[204:207]
    s_add_u32 s85, s10, s50
    s_mul_i32 s90, s83, 458752
    s_waitcnt lgkmcnt(13)
    v_mfma_f32_16x16x32_bf16 v[92:95], v[76:79], v[20:23], v[92:95]
    ds_read_b64_tr_b16 v[68:69], v14 offset:8192
    s_waitcnt lgkmcnt(11)
    v_mfma_f32_16x16x32_bf16 v[96:99], v[76:79], v[24:27], v[96:99]
    ds_read_b64_tr_b16 v[70:71], v14 offset:9216
    s_waitcnt lgkmcnt(11)
    v_mfma_f32_16x16x32_bf16 v[100:103], v[76:79], v[28:31], v[100:103]
    ds_read_b64_tr_b16 v[72:73], v14 offset:24576
    s_waitcnt lgkmcnt(9)
    v_mfma_f32_16x16x32_bf16 v[104:107], v[76:79], v[32:35], v[104:107]
    ds_read_b64_tr_b16 v[74:75], v14 offset:25600
    v_mfma_f32_16x16x32_bf16 v[168:171], v[80:83], v[32:35], v[168:171]
    ds_read_b64_tr_b16 v[76:77], v15 offset:8192
    v_mfma_f32_16x16x32_bf16 v[164:167], v[80:83], v[28:31], v[164:167]
    ds_read_b64_tr_b16 v[78:79], v15 offset:9216
    v_mfma_f32_16x16x32_bf16 v[160:163], v[80:83], v[24:27], v[160:163]
    ds_read_b128 v[36:39], v9 offset:16384
    v_mfma_f32_16x16x32_bf16 v[156:159], v[80:83], v[20:23], v[156:159]
    ds_read_b64_tr_b16 v[80:81], v15 offset:24576
    v_mfma_f32_16x16x32_bf16 v[108:111], v[84:87], v[20:23], v[108:111]
    ds_read_b64_tr_b16 v[82:83], v15 offset:25600
    v_mfma_f32_16x16x32_bf16 v[112:115], v[84:87], v[24:27], v[112:115]
    ds_read_b128 v[40:43], v9 offset:18432
    v_mfma_f32_16x16x32_bf16 v[116:119], v[84:87], v[28:31], v[116:119]
    ds_read_b128 v[44:47], v9 offset:20480
    v_mfma_f32_16x16x32_bf16 v[120:123], v[84:87], v[32:35], v[120:123]
    ds_read_b64_tr_b16 v[84:85], v16 offset:8192
    v_mfma_f32_16x16x32_bf16 v[184:187], v[88:91], v[32:35], v[184:187]
    ds_read_b64_tr_b16 v[86:87], v16 offset:9216
    v_mfma_f32_16x16x32_bf16 v[180:183], v[88:91], v[28:31], v[180:183]
    ds_read_b128 v[48:51], v9 offset:22528
    v_mfma_f32_16x16x32_bf16 v[176:179], v[88:91], v[24:27], v[176:179]
    s_lshl_b32 s91, s83, 13
    s_mov_b32 s44, 0x6543210
    v_mfma_f32_16x16x32_bf16 v[172:175], v[88:91], v[20:23], v[172:175]
    ds_read_b64_tr_b16 v[88:89], v16 offset:24576
    v_mfma_f32_16x16x32_bf16 v[124:127], v[52:55], v[20:23], v[124:127]
    ds_read_b64_tr_b16 v[90:91], v16 offset:25600
    v_mfma_f32_16x16x32_bf16 v[128:131], v[52:55], v[24:27], v[128:131]
    s_mov_b32 s45, 0x10654321
    s_and_b32 s10, s5, 7
    v_mfma_f32_16x16x32_bf16 v[132:135], v[52:55], v[28:31], v[132:135]
    s_lshl_b32 s10, s10, 2
    s_lshr_b64 s[44:45], s[44:45], s10
    v_mfma_f32_16x16x32_bf16 v[136:139], v[52:55], v[32:35], v[136:139]
    ds_read_b64_tr_b16 v[52:53], v17 offset:8192
    s_waitcnt lgkmcnt(15)
    v_mfma_f32_16x16x32_bf16 v[200:203], v[56:59], v[32:35], v[200:203]
    ds_read_b64_tr_b16 v[54:55], v17 offset:9216
    v_mfma_f32_16x16x32_bf16 v[196:199], v[56:59], v[28:31], v[196:199]
    s_bfe_u32 s10, s44, 0x30000
    s_lshl_b32 s36, s10, 12
    v_mfma_f32_16x16x32_bf16 v[192:195], v[56:59], v[24:27], v[192:195]
    s_bfe_u32 s10, s44, 0x30004
    s_lshl_b32 s37, s10, 12
    v_mfma_f32_16x16x32_bf16 v[188:191], v[56:59], v[20:23], v[188:191]
    ds_read_b64_tr_b16 v[56:57], v17 offset:24576
    v_mfma_f32_16x16x32_bf16 v[140:143], v[60:63], v[20:23], v[140:143]
    ds_read_b64_tr_b16 v[58:59], v17 offset:25600
    v_mfma_f32_16x16x32_bf16 v[144:147], v[60:63], v[24:27], v[144:147]
    s_bfe_u32 s10, s44, 0x30008
    s_lshl_b32 s38, s10, 12
    v_mfma_f32_16x16x32_bf16 v[148:151], v[60:63], v[28:31], v[148:151]
    s_bfe_u32 s10, s44, 0x3000c
    s_lshl_b32 s39, s10, 12
    v_mfma_f32_16x16x32_bf16 v[152:155], v[60:63], v[32:35], v[152:155]
    s_bfe_u32 s10, s44, 0x30010
    s_lshl_b32 s40, s10, 12
    v_mfma_f32_16x16x32_bf16 v[216:219], v[64:67], v[32:35], v[216:219]
    s_bfe_u32 s10, s44, 0x30014
    s_lshl_b32 s41, s10, 12
    v_mfma_f32_16x16x32_bf16 v[212:215], v[64:67], v[28:31], v[212:215]
    s_bfe_u32 s10, s44, 0x30018
    s_lshl_b32 s42, s10, 12
    v_mfma_f32_16x16x32_bf16 v[208:211], v[64:67], v[24:27], v[208:211]
    v_lshlrev_b32 v240, 4, v1
    v_mfma_f32_16x16x32_bf16 v[204:207], v[64:67], v[20:23], v[204:207]
    v_lshrrev_b32 v18, 3, v1
    s_waitcnt lgkmcnt(0)
    s_barrier
    v_mfma_f32_16x16x32_bf16 v[92:95], v[68:71], v[36:39], v[92:95]
    ds_read_b64_tr_b16 v[60:61], v10 offset:0
    v_mfma_f32_16x16x32_bf16 v[96:99], v[68:71], v[40:43], v[96:99]
    ds_read_b64_tr_b16 v[62:63], v10 offset:1024
    v_mfma_f32_16x16x32_bf16 v[100:103], v[68:71], v[44:47], v[100:103]
    ds_read_b64_tr_b16 v[64:65], v10 offset:16384
    v_mfma_f32_16x16x32_bf16 v[104:107], v[68:71], v[48:51], v[104:107]
    ds_read_b64_tr_b16 v[66:67], v10 offset:17408
    v_mfma_f32_16x16x32_bf16 v[168:171], v[72:75], v[48:51], v[168:171]
    ds_read_b64_tr_b16 v[68:69], v11 offset:0
    v_mfma_f32_16x16x32_bf16 v[164:167], v[72:75], v[44:47], v[164:167]
    ds_read_b64_tr_b16 v[70:71], v11 offset:1024
    v_mfma_f32_16x16x32_bf16 v[160:163], v[72:75], v[40:43], v[160:163]
    ds_read_b128 v[20:23], v8 offset:32768
    v_mfma_f32_16x16x32_bf16 v[156:159], v[72:75], v[36:39], v[156:159]
    ds_read_b64_tr_b16 v[72:73], v11 offset:16384
    v_mfma_f32_16x16x32_bf16 v[108:111], v[76:79], v[36:39], v[108:111]
    ds_read_b64_tr_b16 v[74:75], v11 offset:17408
    v_mfma_f32_16x16x32_bf16 v[112:115], v[76:79], v[40:43], v[112:115]
    ds_read_b128 v[24:27], v8 offset:34816
    v_mfma_f32_16x16x32_bf16 v[116:119], v[76:79], v[44:47], v[116:119]
    ds_read_b128 v[28:31], v8 offset:36864
    v_mfma_f32_16x16x32_bf16 v[120:123], v[76:79], v[48:51], v[120:123]
    ds_read_b64_tr_b16 v[76:77], v12 offset:0
    v_mfma_f32_16x16x32_bf16 v[184:187], v[80:83], v[48:51], v[184:187]
    ds_read_b64_tr_b16 v[78:79], v12 offset:1024
    v_mfma_f32_16x16x32_bf16 v[180:183], v[80:83], v[44:47], v[180:183]
    ds_read_b128 v[32:35], v8 offset:38912
    v_mfma_f32_16x16x32_bf16 v[176:179], v[80:83], v[40:43], v[176:179]
    v_lshlrev_b32 v18, 10, v18
    v_mfma_f32_16x16x32_bf16 v[172:175], v[80:83], v[36:39], v[172:175]
    ds_read_b64_tr_b16 v[80:81], v12 offset:16384
    v_mfma_f32_16x16x32_bf16 v[124:127], v[84:87], v[36:39], v[124:127]
    ds_read_b64_tr_b16 v[82:83], v12 offset:17408
    v_mfma_f32_16x16x32_bf16 v[128:131], v[84:87], v[40:43], v[128:131]
    v_bfe_u32 v19, v1, 4, 1
    v_mfma_f32_16x16x32_bf16 v[132:135], v[84:87], v[44:47], v[132:135]
    v_lshlrev_b32 v19, 2, v19
    v_mfma_f32_16x16x32_bf16 v[136:139], v[84:87], v[48:51], v[136:139]
    ds_read_b64_tr_b16 v[84:85], v13 offset:0
    v_mfma_f32_16x16x32_bf16 v[200:203], v[88:91], v[48:51], v[200:203]
    ds_read_b64_tr_b16 v[86:87], v13 offset:1024
    v_mfma_f32_16x16x32_bf16 v[196:199], v[88:91], v[44:47], v[196:199]
    v_and_b32 v7, 7, v1
    v_mfma_f32_16x16x32_bf16 v[192:195], v[88:91], v[40:43], v[192:195]
    v_xor_b32 v7, v7, v19
    v_mfma_f32_16x16x32_bf16 v[188:191], v[88:91], v[36:39], v[188:191]
    ds_read_b64_tr_b16 v[88:89], v13 offset:16384
    v_mfma_f32_16x16x32_bf16 v[140:143], v[52:55], v[36:39], v[140:143]
    ds_read_b64_tr_b16 v[90:91], v13 offset:17408
    v_mfma_f32_16x16x32_bf16 v[144:147], v[52:55], v[40:43], v[144:147]
    v_lshl_add_u32 v18, v7, 4, v18
    v_mfma_f32_16x16x32_bf16 v[148:151], v[52:55], v[44:47], v[148:151]
    v_add_u32 v241, s11, v18
    v_mfma_f32_16x16x32_bf16 v[152:155], v[52:55], v[48:51], v[152:155]
    v_lshrrev_b32 v18, 5, v1
    v_mfma_f32_16x16x32_bf16 v[216:219], v[56:59], v[48:51], v[216:219]
    v_bfe_u32 v19, v1, 2, 2
    v_mfma_f32_16x16x32_bf16 v[212:215], v[56:59], v[44:47], v[212:215]
    v_lshl_add_u32 v18, v18, 2, v19
    v_mfma_f32_16x16x32_bf16 v[208:211], v[56:59], v[40:43], v[208:211]
    v_lshlrev_b32 v18, 7, v18
    v_mfma_f32_16x16x32_bf16 v[204:207], v[56:59], v[36:39], v[204:207]
    v_bfe_u32 v19, v1, 3, 1
    s_waitcnt lgkmcnt(13)
    v_mfma_f32_16x16x32_bf16 v[92:95], v[60:63], v[20:23], v[92:95]
    ds_read_b64_tr_b16 v[52:53], v10 offset:8192
    s_waitcnt lgkmcnt(11)
    v_mfma_f32_16x16x32_bf16 v[96:99], v[60:63], v[24:27], v[96:99]
    ds_read_b64_tr_b16 v[54:55], v10 offset:9216
    s_waitcnt lgkmcnt(11)
    v_mfma_f32_16x16x32_bf16 v[100:103], v[60:63], v[28:31], v[100:103]
    ds_read_b64_tr_b16 v[56:57], v10 offset:24576
    s_waitcnt lgkmcnt(9)
    v_mfma_f32_16x16x32_bf16 v[104:107], v[60:63], v[32:35], v[104:107]
    ds_read_b64_tr_b16 v[58:59], v10 offset:25600
    v_mfma_f32_16x16x32_bf16 v[168:171], v[64:67], v[32:35], v[168:171]
    ds_read_b64_tr_b16 v[60:61], v11 offset:8192
    v_mfma_f32_16x16x32_bf16 v[164:167], v[64:67], v[28:31], v[164:167]
    ds_read_b64_tr_b16 v[62:63], v11 offset:9216
    v_mfma_f32_16x16x32_bf16 v[160:163], v[64:67], v[24:27], v[160:163]
    ds_read_b128 v[36:39], v9 offset:32768
    v_mfma_f32_16x16x32_bf16 v[156:159], v[64:67], v[20:23], v[156:159]
    ds_read_b64_tr_b16 v[64:65], v11 offset:24576
    v_mfma_f32_16x16x32_bf16 v[108:111], v[68:71], v[20:23], v[108:111]
    ds_read_b64_tr_b16 v[66:67], v11 offset:25600
    v_mfma_f32_16x16x32_bf16 v[112:115], v[68:71], v[24:27], v[112:115]
    ds_read_b128 v[40:43], v9 offset:34816
    v_mfma_f32_16x16x32_bf16 v[116:119], v[68:71], v[28:31], v[116:119]
    ds_read_b128 v[44:47], v9 offset:36864
    v_mfma_f32_16x16x32_bf16 v[120:123], v[68:71], v[32:35], v[120:123]
    ds_read_b64_tr_b16 v[68:69], v12 offset:8192
    v_mfma_f32_16x16x32_bf16 v[184:187], v[72:75], v[32:35], v[184:187]
    ds_read_b64_tr_b16 v[70:71], v12 offset:9216
    v_mfma_f32_16x16x32_bf16 v[180:183], v[72:75], v[28:31], v[180:183]
    ds_read_b128 v[48:51], v9 offset:38912
    v_mfma_f32_16x16x32_bf16 v[176:179], v[72:75], v[24:27], v[176:179]
    v_lshl_add_u32 v18, v19, 6, v18
    v_mfma_f32_16x16x32_bf16 v[172:175], v[72:75], v[20:23], v[172:175]
    ds_read_b64_tr_b16 v[72:73], v12 offset:24576
    v_mfma_f32_16x16x32_bf16 v[124:127], v[76:79], v[20:23], v[124:127]
    ds_read_b64_tr_b16 v[74:75], v12 offset:25600
    v_mfma_f32_16x16x32_bf16 v[128:131], v[76:79], v[24:27], v[128:131]
    v_bfe_u32 v19, v1, 4, 1
    v_mfma_f32_16x16x32_bf16 v[132:135], v[76:79], v[28:31], v[132:135]
    v_lshl_add_u32 v18, v19, 5, v18
    v_mfma_f32_16x16x32_bf16 v[136:139], v[76:79], v[32:35], v[136:139]
    ds_read_b64_tr_b16 v[76:77], v13 offset:8192
    s_waitcnt lgkmcnt(15)
    v_mfma_f32_16x16x32_bf16 v[200:203], v[80:83], v[32:35], v[200:203]
    ds_read_b64_tr_b16 v[78:79], v13 offset:9216
    v_mfma_f32_16x16x32_bf16 v[196:199], v[80:83], v[28:31], v[196:199]
    v_and_b32 v19, 1, v1
    v_mfma_f32_16x16x32_bf16 v[192:195], v[80:83], v[24:27], v[192:195]
    v_lshl_add_u32 v18, v19, 4, v18
    v_mfma_f32_16x16x32_bf16 v[188:191], v[80:83], v[20:23], v[188:191]
    ds_read_b64_tr_b16 v[80:81], v13 offset:24576
    v_mfma_f32_16x16x32_bf16 v[140:143], v[84:87], v[20:23], v[140:143]
    ds_read_b64_tr_b16 v[82:83], v13 offset:25600
    v_mfma_f32_16x16x32_bf16 v[144:147], v[84:87], v[24:27], v[144:147]
    v_bfe_u32 v19, v1, 1, 1
    v_mfma_f32_16x16x32_bf16 v[148:151], v[84:87], v[28:31], v[148:151]
    v_lshl_add_u32 v18, v19, 3, v18
    v_mfma_f32_16x16x32_bf16 v[152:155], v[84:87], v[32:35], v[152:155]
    v_xor_b32 v18, s12, v18
    v_mfma_f32_16x16x32_bf16 v[216:219], v[88:91], v[32:35], v[216:219]
    s_lshl_b32 s12, s12, 8
    v_add_u32 v242, s12, v18
    v_mfma_f32_16x16x32_bf16 v[212:215], v[88:91], v[28:31], v[212:215]
    s_lshl_b32 s10, s3, 2
    s_add_u32 s10, s10, 65408
    v_mfma_f32_16x16x32_bf16 v[208:211], v[88:91], v[24:27], v[208:211]
    v_mov_b32 v243, s10
    v_mfma_f32_16x16x32_bf16 v[204:207], v[88:91], v[20:23], v[204:207]
    s_waitcnt lgkmcnt(0)
    s_barrier
    v_mfma_f32_16x16x32_bf16 v[92:95], v[52:55], v[36:39], v[92:95]
    ds_read_b64_tr_b16 v[84:85], v10 offset:32768
    v_mfma_f32_16x16x32_bf16 v[96:99], v[52:55], v[40:43], v[96:99]
    ds_read_b64_tr_b16 v[86:87], v10 offset:33792
    v_mfma_f32_16x16x32_bf16 v[100:103], v[52:55], v[44:47], v[100:103]
    ds_read_b64_tr_b16 v[88:89], v10 offset:49152
    v_mfma_f32_16x16x32_bf16 v[104:107], v[52:55], v[48:51], v[104:107]
    ds_read_b64_tr_b16 v[90:91], v10 offset:50176
    v_mfma_f32_16x16x32_bf16 v[168:171], v[56:59], v[48:51], v[168:171]
    ds_read_b64_tr_b16 v[52:53], v11 offset:32768
    v_mfma_f32_16x16x32_bf16 v[164:167], v[56:59], v[44:47], v[164:167]
    ds_read_b64_tr_b16 v[54:55], v11 offset:33792
    v_mfma_f32_16x16x32_bf16 v[160:163], v[56:59], v[40:43], v[160:163]
    ds_read_b128 v[20:23], v8 offset:0
    v_mfma_f32_16x16x32_bf16 v[156:159], v[56:59], v[36:39], v[156:159]
    ds_read_b64_tr_b16 v[56:57], v11 offset:49152
    v_mfma_f32_16x16x32_bf16 v[108:111], v[60:63], v[36:39], v[108:111]
    ds_read_b64_tr_b16 v[58:59], v11 offset:50176
    v_mfma_f32_16x16x32_bf16 v[112:115], v[60:63], v[40:43], v[112:115]
    ds_read_b128 v[24:27], v8 offset:2048
    v_mfma_f32_16x16x32_bf16 v[116:119], v[60:63], v[44:47], v[116:119]
    ds_read_b128 v[28:31], v8 offset:4096
    v_mfma_f32_16x16x32_bf16 v[120:123], v[60:63], v[48:51], v[120:123]
    ds_read_b64_tr_b16 v[60:61], v12 offset:32768
    v_mfma_f32_16x16x32_bf16 v[184:187], v[64:67], v[48:51], v[184:187]
    ds_read_b64_tr_b16 v[62:63], v12 offset:33792
    v_mfma_f32_16x16x32_bf16 v[180:183], v[64:67], v[44:47], v[180:183]
    ds_read_b128 v[32:35], v8 offset:6144
    v_mfma_f32_16x16x32_bf16 v[176:179], v[64:67], v[40:43], v[176:179]
    v_mfma_f32_16x16x32_bf16 v[172:175], v[64:67], v[36:39], v[172:175]
    ds_read_b64_tr_b16 v[64:65], v12 offset:49152
    v_mfma_f32_16x16x32_bf16 v[124:127], v[68:71], v[36:39], v[124:127]
    ds_read_b64_tr_b16 v[66:67], v12 offset:50176
    v_mfma_f32_16x16x32_bf16 v[128:131], v[68:71], v[40:43], v[128:131]
    v_mfma_f32_16x16x32_bf16 v[132:135], v[68:71], v[44:47], v[132:135]
    v_mfma_f32_16x16x32_bf16 v[136:139], v[68:71], v[48:51], v[136:139]
    ds_read_b64_tr_b16 v[68:69], v13 offset:32768
    v_mfma_f32_16x16x32_bf16 v[200:203], v[72:75], v[48:51], v[200:203]
    ds_read_b64_tr_b16 v[70:71], v13 offset:33792
    v_mfma_f32_16x16x32_bf16 v[196:199], v[72:75], v[44:47], v[196:199]
    v_mfma_f32_16x16x32_bf16 v[192:195], v[72:75], v[40:43], v[192:195]
    v_mfma_f32_16x16x32_bf16 v[188:191], v[72:75], v[36:39], v[188:191]
    ds_read_b64_tr_b16 v[72:73], v13 offset:49152
    v_mfma_f32_16x16x32_bf16 v[140:143], v[76:79], v[36:39], v[140:143]
    ds_read_b64_tr_b16 v[74:75], v13 offset:50176
    v_mfma_f32_16x16x32_bf16 v[144:147], v[76:79], v[40:43], v[144:147]
    v_mfma_f32_16x16x32_bf16 v[148:151], v[76:79], v[44:47], v[148:151]
    v_mfma_f32_16x16x32_bf16 v[152:155], v[76:79], v[48:51], v[152:155]
    v_mfma_f32_16x16x32_bf16 v[216:219], v[80:83], v[48:51], v[216:219]
    v_mfma_f32_16x16x32_bf16 v[212:215], v[80:83], v[44:47], v[212:215]
    v_mfma_f32_16x16x32_bf16 v[208:211], v[80:83], v[40:43], v[208:211]
    v_mfma_f32_16x16x32_bf16 v[204:207], v[80:83], v[36:39], v[204:207]
    s_waitcnt lgkmcnt(13)
    v_mfma_f32_16x16x32_bf16 v[92:95], v[84:87], v[20:23], v[92:95]
    ds_read_b64_tr_b16 v[76:77], v10 offset:40960
    s_waitcnt lgkmcnt(11)
    v_mfma_f32_16x16x32_bf16 v[96:99], v[84:87], v[24:27], v[96:99]
    ds_read_b64_tr_b16 v[78:79], v10 offset:41984
    s_waitcnt lgkmcnt(11)
    v_mfma_f32_16x16x32_bf16 v[100:103], v[84:87], v[28:31], v[100:103]
    ds_read_b64_tr_b16 v[80:81], v10 offset:57344
    s_waitcnt lgkmcnt(9)
    v_mfma_f32_16x16x32_bf16 v[104:107], v[84:87], v[32:35], v[104:107]
    ds_read_b64_tr_b16 v[82:83], v10 offset:58368
    v_mfma_f32_16x16x32_bf16 v[168:171], v[88:91], v[32:35], v[168:171]
    ds_read_b64_tr_b16 v[84:85], v11 offset:40960
    v_mfma_f32_16x16x32_bf16 v[164:167], v[88:91], v[28:31], v[164:167]
    ds_read_b64_tr_b16 v[86:87], v11 offset:41984
    v_mfma_f32_16x16x32_bf16 v[160:163], v[88:91], v[24:27], v[160:163]
    ds_read_b128 v[36:39], v9 offset:0
    v_mfma_f32_16x16x32_bf16 v[156:159], v[88:91], v[20:23], v[156:159]
    ds_read_b64_tr_b16 v[88:89], v11 offset:57344
    v_mfma_f32_16x16x32_bf16 v[108:111], v[52:55], v[20:23], v[108:111]
    ds_read_b64_tr_b16 v[90:91], v11 offset:58368
    v_mfma_f32_16x16x32_bf16 v[112:115], v[52:55], v[24:27], v[112:115]
    ds_read_b128 v[40:43], v9 offset:2048
    v_mfma_f32_16x16x32_bf16 v[116:119], v[52:55], v[28:31], v[116:119]
    ds_read_b128 v[44:47], v9 offset:4096
    v_mfma_f32_16x16x32_bf16 v[120:123], v[52:55], v[32:35], v[120:123]
    ds_read_b64_tr_b16 v[52:53], v12 offset:40960
    v_mfma_f32_16x16x32_bf16 v[184:187], v[56:59], v[32:35], v[184:187]
    ds_read_b64_tr_b16 v[54:55], v12 offset:41984
    v_mfma_f32_16x16x32_bf16 v[180:183], v[56:59], v[28:31], v[180:183]
    ds_read_b128 v[48:51], v9 offset:6144
    v_mfma_f32_16x16x32_bf16 v[176:179], v[56:59], v[24:27], v[176:179]
    v_mfma_f32_16x16x32_bf16 v[172:175], v[56:59], v[20:23], v[172:175]
    ds_read_b64_tr_b16 v[56:57], v12 offset:57344
    v_mfma_f32_16x16x32_bf16 v[124:127], v[60:63], v[20:23], v[124:127]
    ds_read_b64_tr_b16 v[58:59], v12 offset:58368
    v_mfma_f32_16x16x32_bf16 v[128:131], v[60:63], v[24:27], v[128:131]
    v_mfma_f32_16x16x32_bf16 v[132:135], v[60:63], v[28:31], v[132:135]
    v_mfma_f32_16x16x32_bf16 v[136:139], v[60:63], v[32:35], v[136:139]
    ds_read_b64_tr_b16 v[60:61], v13 offset:40960
    s_waitcnt lgkmcnt(15)
    v_mfma_f32_16x16x32_bf16 v[200:203], v[64:67], v[32:35], v[200:203]
    ds_read_b64_tr_b16 v[62:63], v13 offset:41984
    v_mfma_f32_16x16x32_bf16 v[196:199], v[64:67], v[28:31], v[196:199]
    v_mfma_f32_16x16x32_bf16 v[192:195], v[64:67], v[24:27], v[192:195]
    v_mfma_f32_16x16x32_bf16 v[188:191], v[64:67], v[20:23], v[188:191]
    ds_read_b64_tr_b16 v[64:65], v13 offset:57344
    v_mfma_f32_16x16x32_bf16 v[140:143], v[68:71], v[20:23], v[140:143]
    ds_read_b64_tr_b16 v[66:67], v13 offset:58368
    v_mfma_f32_16x16x32_bf16 v[144:147], v[68:71], v[24:27], v[144:147]
    v_mfma_f32_16x16x32_bf16 v[148:151], v[68:71], v[28:31], v[148:151]
    v_mfma_f32_16x16x32_bf16 v[152:155], v[68:71], v[32:35], v[152:155]
    v_mfma_f32_16x16x32_bf16 v[216:219], v[72:75], v[32:35], v[216:219]
    v_mfma_f32_16x16x32_bf16 v[212:215], v[72:75], v[28:31], v[212:215]
    v_mfma_f32_16x16x32_bf16 v[208:211], v[72:75], v[24:27], v[208:211]
    v_mfma_f32_16x16x32_bf16 v[204:207], v[72:75], v[20:23], v[204:207]
    s_waitcnt lgkmcnt(0)
    s_barrier
    v_mfma_f32_16x16x32_bf16 v[92:95], v[76:79], v[36:39], v[92:95]
    ds_read_b64_tr_b16 v[68:69], v14 offset:0
    v_mfma_f32_16x16x32_bf16 v[96:99], v[76:79], v[40:43], v[96:99]
    ds_read_b64_tr_b16 v[70:71], v14 offset:1024
    v_mfma_f32_16x16x32_bf16 v[100:103], v[76:79], v[44:47], v[100:103]
    ds_read_b64_tr_b16 v[72:73], v14 offset:16384
    v_mfma_f32_16x16x32_bf16 v[104:107], v[76:79], v[48:51], v[104:107]
    ds_read_b64_tr_b16 v[74:75], v14 offset:17408
    v_mfma_f32_16x16x32_bf16 v[168:171], v[80:83], v[48:51], v[168:171]
    ds_read_b64_tr_b16 v[76:77], v15 offset:0
    v_mfma_f32_16x16x32_bf16 v[164:167], v[80:83], v[44:47], v[164:167]
    ds_read_b64_tr_b16 v[78:79], v15 offset:1024
    v_mfma_f32_16x16x32_bf16 v[160:163], v[80:83], v[40:43], v[160:163]
    ds_read_b128 v[20:23], v8 offset:16384
    v_mfma_f32_16x16x32_bf16 v[156:159], v[80:83], v[36:39], v[156:159]
    ds_read_b64_tr_b16 v[80:81], v15 offset:16384
    v_mfma_f32_16x16x32_bf16 v[108:111], v[84:87], v[36:39], v[108:111]
    ds_read_b64_tr_b16 v[82:83], v15 offset:17408
    v_mfma_f32_16x16x32_bf16 v[112:115], v[84:87], v[40:43], v[112:115]
    ds_read_b128 v[24:27], v8 offset:18432
    v_mfma_f32_16x16x32_bf16 v[116:119], v[84:87], v[44:47], v[116:119]
    ds_read_b128 v[28:31], v8 offset:20480
    v_mfma_f32_16x16x32_bf16 v[120:123], v[84:87], v[48:51], v[120:123]
    ds_read_b64_tr_b16 v[84:85], v16 offset:0
    v_mfma_f32_16x16x32_bf16 v[184:187], v[88:91], v[48:51], v[184:187]
    ds_read_b64_tr_b16 v[86:87], v16 offset:1024
    v_mfma_f32_16x16x32_bf16 v[180:183], v[88:91], v[44:47], v[180:183]
    ds_read_b128 v[32:35], v8 offset:22528
    v_mfma_f32_16x16x32_bf16 v[176:179], v[88:91], v[40:43], v[176:179]
    v_mfma_f32_16x16x32_bf16 v[172:175], v[88:91], v[36:39], v[172:175]
    ds_read_b64_tr_b16 v[88:89], v16 offset:16384
    v_mfma_f32_16x16x32_bf16 v[124:127], v[52:55], v[36:39], v[124:127]
    ds_read_b64_tr_b16 v[90:91], v16 offset:17408
    v_mfma_f32_16x16x32_bf16 v[128:131], v[52:55], v[40:43], v[128:131]
    v_mfma_f32_16x16x32_bf16 v[132:135], v[52:55], v[44:47], v[132:135]
    v_mfma_f32_16x16x32_bf16 v[136:139], v[52:55], v[48:51], v[136:139]
    ds_read_b64_tr_b16 v[52:53], v17 offset:0
    v_mfma_f32_16x16x32_bf16 v[200:203], v[56:59], v[48:51], v[200:203]
    ds_read_b64_tr_b16 v[54:55], v17 offset:1024
    v_mfma_f32_16x16x32_bf16 v[196:199], v[56:59], v[44:47], v[196:199]
    v_mfma_f32_16x16x32_bf16 v[192:195], v[56:59], v[40:43], v[192:195]
    v_mfma_f32_16x16x32_bf16 v[188:191], v[56:59], v[36:39], v[188:191]
    ds_read_b64_tr_b16 v[56:57], v17 offset:16384
    v_mfma_f32_16x16x32_bf16 v[140:143], v[60:63], v[36:39], v[140:143]
    ds_read_b64_tr_b16 v[58:59], v17 offset:17408
    v_mfma_f32_16x16x32_bf16 v[144:147], v[60:63], v[40:43], v[144:147]
    v_mfma_f32_16x16x32_bf16 v[148:151], v[60:63], v[44:47], v[148:151]
    v_mfma_f32_16x16x32_bf16 v[152:155], v[60:63], v[48:51], v[152:155]
    v_mfma_f32_16x16x32_bf16 v[216:219], v[64:67], v[48:51], v[216:219]
    v_mfma_f32_16x16x32_bf16 v[212:215], v[64:67], v[44:47], v[212:215]
    v_mfma_f32_16x16x32_bf16 v[208:211], v[64:67], v[40:43], v[208:211]
    v_mfma_f32_16x16x32_bf16 v[204:207], v[64:67], v[36:39], v[204:207]
    s_waitcnt lgkmcnt(13)
    v_mfma_f32_16x16x32_bf16 v[92:95], v[68:71], v[20:23], v[92:95]
    ds_read_b64_tr_b16 v[60:61], v14 offset:8192
    s_waitcnt lgkmcnt(11)
    v_mfma_f32_16x16x32_bf16 v[96:99], v[68:71], v[24:27], v[96:99]
    ds_read_b64_tr_b16 v[62:63], v14 offset:9216
    s_waitcnt lgkmcnt(11)
    v_mfma_f32_16x16x32_bf16 v[100:103], v[68:71], v[28:31], v[100:103]
    ds_read_b64_tr_b16 v[64:65], v14 offset:24576
    s_waitcnt lgkmcnt(9)
    v_mfma_f32_16x16x32_bf16 v[104:107], v[68:71], v[32:35], v[104:107]
    ds_read_b64_tr_b16 v[66:67], v14 offset:25600
    v_mfma_f32_16x16x32_bf16 v[168:171], v[72:75], v[32:35], v[168:171]
    ds_read_b64_tr_b16 v[68:69], v15 offset:8192
    v_mfma_f32_16x16x32_bf16 v[164:167], v[72:75], v[28:31], v[164:167]
    ds_read_b64_tr_b16 v[70:71], v15 offset:9216
    v_mfma_f32_16x16x32_bf16 v[160:163], v[72:75], v[24:27], v[160:163]
    ds_read_b128 v[36:39], v9 offset:16384
    v_mfma_f32_16x16x32_bf16 v[156:159], v[72:75], v[20:23], v[156:159]
    ds_read_b64_tr_b16 v[72:73], v15 offset:24576
    v_mfma_f32_16x16x32_bf16 v[108:111], v[76:79], v[20:23], v[108:111]
    ds_read_b64_tr_b16 v[74:75], v15 offset:25600
    v_mfma_f32_16x16x32_bf16 v[112:115], v[76:79], v[24:27], v[112:115]
    ds_read_b128 v[40:43], v9 offset:18432
    v_mfma_f32_16x16x32_bf16 v[116:119], v[76:79], v[28:31], v[116:119]
    ds_read_b128 v[44:47], v9 offset:20480
    v_mfma_f32_16x16x32_bf16 v[120:123], v[76:79], v[32:35], v[120:123]
    ds_read_b64_tr_b16 v[76:77], v16 offset:8192
    v_mfma_f32_16x16x32_bf16 v[184:187], v[80:83], v[32:35], v[184:187]
    ds_read_b64_tr_b16 v[78:79], v16 offset:9216
    v_mfma_f32_16x16x32_bf16 v[180:183], v[80:83], v[28:31], v[180:183]
    ds_read_b128 v[48:51], v9 offset:22528
    v_mfma_f32_16x16x32_bf16 v[176:179], v[80:83], v[24:27], v[176:179]
    v_mfma_f32_16x16x32_bf16 v[172:175], v[80:83], v[20:23], v[172:175]
    ds_read_b64_tr_b16 v[80:81], v16 offset:24576
    v_mfma_f32_16x16x32_bf16 v[124:127], v[84:87], v[20:23], v[124:127]
    ds_read_b64_tr_b16 v[82:83], v16 offset:25600
    v_mfma_f32_16x16x32_bf16 v[128:131], v[84:87], v[24:27], v[128:131]
    v_mfma_f32_16x16x32_bf16 v[132:135], v[84:87], v[28:31], v[132:135]
    v_mfma_f32_16x16x32_bf16 v[136:139], v[84:87], v[32:35], v[136:139]
    ds_read_b64_tr_b16 v[84:85], v17 offset:8192
    s_waitcnt lgkmcnt(15)
    v_mfma_f32_16x16x32_bf16 v[200:203], v[88:91], v[32:35], v[200:203]
    ds_read_b64_tr_b16 v[86:87], v17 offset:9216
    v_mfma_f32_16x16x32_bf16 v[196:199], v[88:91], v[28:31], v[196:199]
    v_mfma_f32_16x16x32_bf16 v[192:195], v[88:91], v[24:27], v[192:195]
    v_mfma_f32_16x16x32_bf16 v[188:191], v[88:91], v[20:23], v[188:191]
    ds_read_b64_tr_b16 v[88:89], v17 offset:24576
    v_mfma_f32_16x16x32_bf16 v[140:143], v[52:55], v[20:23], v[140:143]
    ds_read_b64_tr_b16 v[90:91], v17 offset:25600
    v_mfma_f32_16x16x32_bf16 v[144:147], v[52:55], v[24:27], v[144:147]
    v_mfma_f32_16x16x32_bf16 v[148:151], v[52:55], v[28:31], v[148:151]
    v_mfma_f32_16x16x32_bf16 v[152:155], v[52:55], v[32:35], v[152:155]
    v_mfma_f32_16x16x32_bf16 v[216:219], v[56:59], v[32:35], v[216:219]
    v_mfma_f32_16x16x32_bf16 v[212:215], v[56:59], v[28:31], v[212:215]
    v_mfma_f32_16x16x32_bf16 v[208:211], v[56:59], v[24:27], v[208:211]
    v_mfma_f32_16x16x32_bf16 v[204:207], v[56:59], v[20:23], v[204:207]
    s_waitcnt lgkmcnt(0)
    s_barrier
    v_mfma_f32_16x16x32_bf16 v[92:95], v[60:63], v[36:39], v[92:95]
    ds_read_b64_tr_b16 v[52:53], v10 offset:0
    v_mfma_f32_16x16x32_bf16 v[96:99], v[60:63], v[40:43], v[96:99]
    ds_read_b64_tr_b16 v[54:55], v10 offset:1024
    v_mfma_f32_16x16x32_bf16 v[100:103], v[60:63], v[44:47], v[100:103]
    ds_read_b64_tr_b16 v[56:57], v10 offset:16384
    v_mfma_f32_16x16x32_bf16 v[104:107], v[60:63], v[48:51], v[104:107]
    ds_read_b64_tr_b16 v[58:59], v10 offset:17408
    v_mfma_f32_16x16x32_bf16 v[168:171], v[64:67], v[48:51], v[168:171]
    ds_read_b64_tr_b16 v[60:61], v11 offset:0
    v_mfma_f32_16x16x32_bf16 v[164:167], v[64:67], v[44:47], v[164:167]
    ds_read_b64_tr_b16 v[62:63], v11 offset:1024
    v_mfma_f32_16x16x32_bf16 v[160:163], v[64:67], v[40:43], v[160:163]
    ds_read_b128 v[20:23], v8 offset:32768
    v_mfma_f32_16x16x32_bf16 v[156:159], v[64:67], v[36:39], v[156:159]
    ds_read_b64_tr_b16 v[64:65], v11 offset:16384
    v_mfma_f32_16x16x32_bf16 v[108:111], v[68:71], v[36:39], v[108:111]
    ds_read_b64_tr_b16 v[66:67], v11 offset:17408
    v_mfma_f32_16x16x32_bf16 v[112:115], v[68:71], v[40:43], v[112:115]
    ds_read_b128 v[24:27], v8 offset:34816
    v_mfma_f32_16x16x32_bf16 v[116:119], v[68:71], v[44:47], v[116:119]
    ds_read_b128 v[28:31], v8 offset:36864
    v_mfma_f32_16x16x32_bf16 v[120:123], v[68:71], v[48:51], v[120:123]
    ds_read_b64_tr_b16 v[68:69], v12 offset:0
    v_mfma_f32_16x16x32_bf16 v[184:187], v[72:75], v[48:51], v[184:187]
    ds_read_b64_tr_b16 v[70:71], v12 offset:1024
    v_mfma_f32_16x16x32_bf16 v[180:183], v[72:75], v[44:47], v[180:183]
    ds_read_b128 v[32:35], v8 offset:38912
    v_mfma_f32_16x16x32_bf16 v[176:179], v[72:75], v[40:43], v[176:179]
    v_mfma_f32_16x16x32_bf16 v[172:175], v[72:75], v[36:39], v[172:175]
    ds_read_b64_tr_b16 v[72:73], v12 offset:16384
    v_mfma_f32_16x16x32_bf16 v[124:127], v[76:79], v[36:39], v[124:127]
    ds_read_b64_tr_b16 v[74:75], v12 offset:17408
    v_mfma_f32_16x16x32_bf16 v[128:131], v[76:79], v[40:43], v[128:131]
    v_mfma_f32_16x16x32_bf16 v[132:135], v[76:79], v[44:47], v[132:135]
    v_mfma_f32_16x16x32_bf16 v[136:139], v[76:79], v[48:51], v[136:139]
    ds_read_b64_tr_b16 v[76:77], v13 offset:0
    v_mfma_f32_16x16x32_bf16 v[200:203], v[80:83], v[48:51], v[200:203]
    ds_read_b64_tr_b16 v[78:79], v13 offset:1024
    v_mfma_f32_16x16x32_bf16 v[196:199], v[80:83], v[44:47], v[196:199]
    v_mfma_f32_16x16x32_bf16 v[192:195], v[80:83], v[40:43], v[192:195]
    v_mfma_f32_16x16x32_bf16 v[188:191], v[80:83], v[36:39], v[188:191]
    ds_read_b64_tr_b16 v[80:81], v13 offset:16384
    v_mfma_f32_16x16x32_bf16 v[140:143], v[84:87], v[36:39], v[140:143]
    ds_read_b64_tr_b16 v[82:83], v13 offset:17408
    v_mfma_f32_16x16x32_bf16 v[144:147], v[84:87], v[40:43], v[144:147]
    v_mfma_f32_16x16x32_bf16 v[148:151], v[84:87], v[44:47], v[148:151]
    v_mfma_f32_16x16x32_bf16 v[152:155], v[84:87], v[48:51], v[152:155]
    v_mfma_f32_16x16x32_bf16 v[216:219], v[88:91], v[48:51], v[216:219]
    v_mfma_f32_16x16x32_bf16 v[212:215], v[88:91], v[44:47], v[212:215]
    v_mfma_f32_16x16x32_bf16 v[208:211], v[88:91], v[40:43], v[208:211]
    v_mfma_f32_16x16x32_bf16 v[204:207], v[88:91], v[36:39], v[204:207]
    s_waitcnt lgkmcnt(13)
    v_mfma_f32_16x16x32_bf16 v[92:95], v[52:55], v[20:23], v[92:95]
    ds_read_b64_tr_b16 v[84:85], v10 offset:8192
    s_waitcnt lgkmcnt(11)
    v_mfma_f32_16x16x32_bf16 v[96:99], v[52:55], v[24:27], v[96:99]
    ds_read_b64_tr_b16 v[86:87], v10 offset:9216
    s_waitcnt lgkmcnt(11)
    v_mfma_f32_16x16x32_bf16 v[100:103], v[52:55], v[28:31], v[100:103]
    ds_read_b64_tr_b16 v[88:89], v10 offset:24576
    s_waitcnt lgkmcnt(9)
    v_mfma_f32_16x16x32_bf16 v[104:107], v[52:55], v[32:35], v[104:107]
    ds_read_b64_tr_b16 v[90:91], v10 offset:25600
    v_mfma_f32_16x16x32_bf16 v[168:171], v[56:59], v[32:35], v[168:171]
    ds_read_b64_tr_b16 v[52:53], v11 offset:8192
    v_mfma_f32_16x16x32_bf16 v[164:167], v[56:59], v[28:31], v[164:167]
    ds_read_b64_tr_b16 v[54:55], v11 offset:9216
    v_mfma_f32_16x16x32_bf16 v[160:163], v[56:59], v[24:27], v[160:163]
    ds_read_b128 v[36:39], v9 offset:32768
    v_mfma_f32_16x16x32_bf16 v[156:159], v[56:59], v[20:23], v[156:159]
    ds_read_b64_tr_b16 v[56:57], v11 offset:24576
    v_mfma_f32_16x16x32_bf16 v[108:111], v[60:63], v[20:23], v[108:111]
    ds_read_b64_tr_b16 v[58:59], v11 offset:25600
    v_mfma_f32_16x16x32_bf16 v[112:115], v[60:63], v[24:27], v[112:115]
    ds_read_b128 v[40:43], v9 offset:34816
    v_mfma_f32_16x16x32_bf16 v[116:119], v[60:63], v[28:31], v[116:119]
    ds_read_b128 v[44:47], v9 offset:36864
    v_mfma_f32_16x16x32_bf16 v[120:123], v[60:63], v[32:35], v[120:123]
    ds_read_b64_tr_b16 v[60:61], v12 offset:8192
    v_mfma_f32_16x16x32_bf16 v[184:187], v[64:67], v[32:35], v[184:187]
    ds_read_b64_tr_b16 v[62:63], v12 offset:9216
    v_mfma_f32_16x16x32_bf16 v[180:183], v[64:67], v[28:31], v[180:183]
    ds_read_b128 v[48:51], v9 offset:38912
    v_mfma_f32_16x16x32_bf16 v[176:179], v[64:67], v[24:27], v[176:179]
    v_mfma_f32_16x16x32_bf16 v[172:175], v[64:67], v[20:23], v[172:175]
    ds_read_b64_tr_b16 v[64:65], v12 offset:24576
    v_mfma_f32_16x16x32_bf16 v[124:127], v[68:71], v[20:23], v[124:127]
    ds_read_b64_tr_b16 v[66:67], v12 offset:25600
    v_mfma_f32_16x16x32_bf16 v[128:131], v[68:71], v[24:27], v[128:131]
    v_mfma_f32_16x16x32_bf16 v[132:135], v[68:71], v[28:31], v[132:135]
    v_mfma_f32_16x16x32_bf16 v[136:139], v[68:71], v[32:35], v[136:139]
    ds_read_b64_tr_b16 v[68:69], v13 offset:8192
    s_waitcnt lgkmcnt(15)
    v_mfma_f32_16x16x32_bf16 v[200:203], v[72:75], v[32:35], v[200:203]
    ds_read_b64_tr_b16 v[70:71], v13 offset:9216
    v_mfma_f32_16x16x32_bf16 v[196:199], v[72:75], v[28:31], v[196:199]
    v_mfma_f32_16x16x32_bf16 v[192:195], v[72:75], v[24:27], v[192:195]
    v_mfma_f32_16x16x32_bf16 v[188:191], v[72:75], v[20:23], v[188:191]
    ds_read_b64_tr_b16 v[72:73], v13 offset:24576
    v_mfma_f32_16x16x32_bf16 v[140:143], v[76:79], v[20:23], v[140:143]
    ds_read_b64_tr_b16 v[74:75], v13 offset:25600
    v_mfma_f32_16x16x32_bf16 v[144:147], v[76:79], v[24:27], v[144:147]
    v_mfma_f32_16x16x32_bf16 v[148:151], v[76:79], v[28:31], v[148:151]
    v_mfma_f32_16x16x32_bf16 v[152:155], v[76:79], v[32:35], v[152:155]
    v_mfma_f32_16x16x32_bf16 v[216:219], v[80:83], v[32:35], v[216:219]
    v_mfma_f32_16x16x32_bf16 v[212:215], v[80:83], v[28:31], v[212:215]
    v_mfma_f32_16x16x32_bf16 v[208:211], v[80:83], v[24:27], v[208:211]
    v_mfma_f32_16x16x32_bf16 v[204:207], v[80:83], v[20:23], v[204:207]
    s_waitcnt lgkmcnt(0)
    s_barrier
    v_mfma_f32_16x16x32_bf16 v[92:95], v[84:87], v[36:39], v[92:95]
    ds_read_b64_tr_b16 v[76:77], v10 offset:32768
    v_mfma_f32_16x16x32_bf16 v[96:99], v[84:87], v[40:43], v[96:99]
    ds_read_b64_tr_b16 v[78:79], v10 offset:33792
    v_mfma_f32_16x16x32_bf16 v[100:103], v[84:87], v[44:47], v[100:103]
    ds_read_b64_tr_b16 v[80:81], v10 offset:49152
    v_mfma_f32_16x16x32_bf16 v[104:107], v[84:87], v[48:51], v[104:107]
    ds_read_b64_tr_b16 v[82:83], v10 offset:50176
    v_mfma_f32_16x16x32_bf16 v[168:171], v[88:91], v[48:51], v[168:171]
    ds_read_b64_tr_b16 v[84:85], v11 offset:32768
    v_mfma_f32_16x16x32_bf16 v[164:167], v[88:91], v[44:47], v[164:167]
    ds_read_b64_tr_b16 v[86:87], v11 offset:33792
    v_mfma_f32_16x16x32_bf16 v[160:163], v[88:91], v[40:43], v[160:163]
    ds_read_b128 v[20:23], v8 offset:0
    v_mfma_f32_16x16x32_bf16 v[156:159], v[88:91], v[36:39], v[156:159]
    ds_read_b64_tr_b16 v[88:89], v11 offset:49152
    v_mfma_f32_16x16x32_bf16 v[108:111], v[52:55], v[36:39], v[108:111]
    ds_read_b64_tr_b16 v[90:91], v11 offset:50176
    v_mfma_f32_16x16x32_bf16 v[112:115], v[52:55], v[40:43], v[112:115]
    ds_read_b128 v[24:27], v8 offset:2048
    v_mfma_f32_16x16x32_bf16 v[116:119], v[52:55], v[44:47], v[116:119]
    ds_read_b128 v[28:31], v8 offset:4096
    v_mfma_f32_16x16x32_bf16 v[120:123], v[52:55], v[48:51], v[120:123]
    ds_read_b64_tr_b16 v[52:53], v12 offset:32768
    v_mfma_f32_16x16x32_bf16 v[184:187], v[56:59], v[48:51], v[184:187]
    ds_read_b64_tr_b16 v[54:55], v12 offset:33792
    v_mfma_f32_16x16x32_bf16 v[180:183], v[56:59], v[44:47], v[180:183]
    ds_read_b128 v[32:35], v8 offset:6144
    v_mfma_f32_16x16x32_bf16 v[176:179], v[56:59], v[40:43], v[176:179]
    v_and_b32 v228, 31, v1
    v_mfma_f32_16x16x32_bf16 v[172:175], v[56:59], v[36:39], v[172:175]
    ds_read_b64_tr_b16 v[56:57], v12 offset:49152
    v_mfma_f32_16x16x32_bf16 v[124:127], v[60:63], v[36:39], v[124:127]
    ds_read_b64_tr_b16 v[58:59], v12 offset:50176
    v_mfma_f32_16x16x32_bf16 v[128:131], v[60:63], v[40:43], v[128:131]
    v_lshrrev_b32 v229, 5, v1
    v_mfma_f32_16x16x32_bf16 v[132:135], v[60:63], v[44:47], v[132:135]
    v_lshlrev_b32 v230, 4, v229
    v_mfma_f32_16x16x32_bf16 v[136:139], v[60:63], v[48:51], v[136:139]
    ds_read_b64_tr_b16 v[60:61], v13 offset:32768
    v_mfma_f32_16x16x32_bf16 v[200:203], v[64:67], v[48:51], v[200:203]
    ds_read_b64_tr_b16 v[62:63], v13 offset:33792
    v_mfma_f32_16x16x32_bf16 v[196:199], v[64:67], v[44:47], v[196:199]
    v_lshl_add_u32 v228, v228, 10, v230
    v_mfma_f32_16x16x32_bf16 v[192:195], v[64:67], v[40:43], v[192:195]
    buffer_load_dwordx4 v[220:223], v228, s[52:55], s85 offen
    v_mfma_f32_16x16x32_bf16 v[188:191], v[64:67], v[36:39], v[188:191]
    ds_read_b64_tr_b16 v[64:65], v13 offset:49152
    v_mfma_f32_16x16x32_bf16 v[140:143], v[68:71], v[36:39], v[140:143]
    ds_read_b64_tr_b16 v[66:67], v13 offset:50176
    v_mfma_f32_16x16x32_bf16 v[144:147], v[68:71], v[40:43], v[144:147]
    v_add_u32 v230, s50, v230
    v_mfma_f32_16x16x32_bf16 v[148:151], v[68:71], v[44:47], v[148:151]
    global_load_dwordx4 v[224:227], v230, s[32:33]
    v_mfma_f32_16x16x32_bf16 v[152:155], v[68:71], v[48:51], v[152:155]
    v_lshrrev_b32 v18, 4, v1
    v_mfma_f32_16x16x32_bf16 v[216:219], v[72:75], v[48:51], v[216:219]
    v_lshlrev_b32 v18, 9, v18
    v_mfma_f32_16x16x32_bf16 v[212:215], v[72:75], v[44:47], v[212:215]
    v_and_b32 v19, 15, v1
    v_mfma_f32_16x16x32_bf16 v[208:211], v[72:75], v[40:43], v[208:211]
    v_lshl_add_u32 v18, v19, 4, v18
    v_mfma_f32_16x16x32_bf16 v[204:207], v[72:75], v[36:39], v[204:207]
    s_add_u32 s10, s34, 114688
    s_waitcnt lgkmcnt(13)
    v_mfma_f32_16x16x32_bf16 v[92:95], v[76:79], v[20:23], v[92:95]
    ds_read_b64_tr_b16 v[68:69], v10 offset:40960
    s_waitcnt lgkmcnt(11)
    v_mfma_f32_16x16x32_bf16 v[96:99], v[76:79], v[24:27], v[96:99]
    ds_read_b64_tr_b16 v[70:71], v10 offset:41984
    s_waitcnt lgkmcnt(11)
    v_mfma_f32_16x16x32_bf16 v[100:103], v[76:79], v[28:31], v[100:103]
    ds_read_b64_tr_b16 v[72:73], v10 offset:57344
    s_waitcnt lgkmcnt(9)
    v_mfma_f32_16x16x32_bf16 v[104:107], v[76:79], v[32:35], v[104:107]
    ds_read_b64_tr_b16 v[74:75], v10 offset:58368
    v_mfma_f32_16x16x32_bf16 v[168:171], v[80:83], v[32:35], v[168:171]
    ds_read_b64_tr_b16 v[76:77], v11 offset:40960
    v_mfma_f32_16x16x32_bf16 v[164:167], v[80:83], v[28:31], v[164:167]
    ds_read_b64_tr_b16 v[78:79], v11 offset:41984
    v_mfma_f32_16x16x32_bf16 v[160:163], v[80:83], v[24:27], v[160:163]
    ds_read_b128 v[36:39], v9 offset:0
    v_mfma_f32_16x16x32_bf16 v[156:159], v[80:83], v[20:23], v[156:159]
    ds_read_b64_tr_b16 v[80:81], v11 offset:57344
    v_mfma_f32_16x16x32_bf16 v[108:111], v[84:87], v[20:23], v[108:111]
    ds_read_b64_tr_b16 v[82:83], v11 offset:58368
    v_mfma_f32_16x16x32_bf16 v[112:115], v[84:87], v[24:27], v[112:115]
    ds_read_b128 v[40:43], v9 offset:2048
    v_mfma_f32_16x16x32_bf16 v[116:119], v[84:87], v[28:31], v[116:119]
    ds_read_b128 v[44:47], v9 offset:4096
    v_mfma_f32_16x16x32_bf16 v[120:123], v[84:87], v[32:35], v[120:123]
    ds_read_b64_tr_b16 v[84:85], v12 offset:40960
    v_mfma_f32_16x16x32_bf16 v[184:187], v[88:91], v[32:35], v[184:187]
    ds_read_b64_tr_b16 v[86:87], v12 offset:41984
    v_mfma_f32_16x16x32_bf16 v[180:183], v[88:91], v[28:31], v[180:183]
    ds_read_b128 v[48:51], v9 offset:6144
    v_mfma_f32_16x16x32_bf16 v[176:179], v[88:91], v[24:27], v[176:179]
    v_mfma_f32_16x16x32_bf16 v[172:175], v[88:91], v[20:23], v[172:175]
    ds_read_b64_tr_b16 v[88:89], v12 offset:57344
    v_mfma_f32_16x16x32_bf16 v[124:127], v[52:55], v[20:23], v[124:127]
    ds_read_b64_tr_b16 v[90:91], v12 offset:58368
    v_mfma_f32_16x16x32_bf16 v[128:131], v[52:55], v[24:27], v[128:131]
    v_mfma_f32_16x16x32_bf16 v[132:135], v[52:55], v[28:31], v[132:135]
    v_mfma_f32_16x16x32_bf16 v[136:139], v[52:55], v[32:35], v[136:139]
    ds_read_b64_tr_b16 v[52:53], v13 offset:40960
    s_waitcnt lgkmcnt(15)
    v_mfma_f32_16x16x32_bf16 v[200:203], v[56:59], v[32:35], v[200:203]
    ds_read_b64_tr_b16 v[54:55], v13 offset:41984
    v_mfma_f32_16x16x32_bf16 v[196:199], v[56:59], v[28:31], v[196:199]
    v_mfma_f32_16x16x32_bf16 v[192:195], v[56:59], v[24:27], v[192:195]
    v_mfma_f32_16x16x32_bf16 v[188:191], v[56:59], v[20:23], v[188:191]
    ds_read_b64_tr_b16 v[56:57], v13 offset:57344
    v_mfma_f32_16x16x32_bf16 v[140:143], v[60:63], v[20:23], v[140:143]
    ds_read_b64_tr_b16 v[58:59], v13 offset:58368
    v_mfma_f32_16x16x32_bf16 v[144:147], v[60:63], v[24:27], v[144:147]
    v_mfma_f32_16x16x32_bf16 v[148:151], v[60:63], v[28:31], v[148:151]
    v_mfma_f32_16x16x32_bf16 v[152:155], v[60:63], v[32:35], v[152:155]
    v_mfma_f32_16x16x32_bf16 v[216:219], v[64:67], v[32:35], v[216:219]
    v_mfma_f32_16x16x32_bf16 v[212:215], v[64:67], v[28:31], v[212:215]
    v_mfma_f32_16x16x32_bf16 v[208:211], v[64:67], v[24:27], v[208:211]
    v_mfma_f32_16x16x32_bf16 v[204:207], v[64:67], v[20:23], v[204:207]
    s_waitcnt lgkmcnt(0)
    s_barrier
    v_mfma_f32_16x16x32_bf16 v[92:95], v[68:71], v[36:39], v[92:95]
    ds_read_b64_tr_b16 v[60:61], v14 offset:0
    v_mfma_f32_16x16x32_bf16 v[96:99], v[68:71], v[40:43], v[96:99]
    ds_read_b64_tr_b16 v[62:63], v14 offset:1024
    v_mfma_f32_16x16x32_bf16 v[100:103], v[68:71], v[44:47], v[100:103]
    ds_read_b64_tr_b16 v[64:65], v14 offset:16384
    v_mfma_f32_16x16x32_bf16 v[104:107], v[68:71], v[48:51], v[104:107]
    ds_read_b64_tr_b16 v[66:67], v14 offset:17408
    v_mfma_f32_16x16x32_bf16 v[168:171], v[72:75], v[48:51], v[168:171]
    ds_read_b64_tr_b16 v[68:69], v15 offset:0
    v_mfma_f32_16x16x32_bf16 v[164:167], v[72:75], v[44:47], v[164:167]
    ds_read_b64_tr_b16 v[70:71], v15 offset:1024
    v_mfma_f32_16x16x32_bf16 v[160:163], v[72:75], v[40:43], v[160:163]
    ds_read_b128 v[20:23], v8 offset:16384
    v_mfma_f32_16x16x32_bf16 v[156:159], v[72:75], v[36:39], v[156:159]
    ds_read_b64_tr_b16 v[72:73], v15 offset:16384
    v_mfma_f32_16x16x32_bf16 v[108:111], v[76:79], v[36:39], v[108:111]
    ds_read_b64_tr_b16 v[74:75], v15 offset:17408
    v_mfma_f32_16x16x32_bf16 v[112:115], v[76:79], v[40:43], v[112:115]
    ds_read_b128 v[24:27], v8 offset:18432
    v_mfma_f32_16x16x32_bf16 v[116:119], v[76:79], v[44:47], v[116:119]
    ds_read_b128 v[28:31], v8 offset:20480
    v_mfma_f32_16x16x32_bf16 v[120:123], v[76:79], v[48:51], v[120:123]
    ds_read_b64_tr_b16 v[76:77], v14 offset:8192
    v_mfma_f32_16x16x32_bf16 v[184:187], v[80:83], v[48:51], v[184:187]
    ds_read_b64_tr_b16 v[78:79], v14 offset:9216
    v_mfma_f32_16x16x32_bf16 v[180:183], v[80:83], v[44:47], v[180:183]
    ds_read_b128 v[32:35], v8 offset:22528
    v_mfma_f32_16x16x32_bf16 v[176:179], v[80:83], v[40:43], v[176:179]
    s_waitcnt vmcnt(0)
    v_lshlrev_b32 v228, 16, v220
    v_mfma_f32_16x16x32_bf16 v[172:175], v[80:83], v[36:39], v[172:175]
    ds_read_b64_tr_b16 v[80:81], v14 offset:24576
    v_mfma_f32_16x16x32_bf16 v[124:127], v[84:87], v[36:39], v[124:127]
    ds_read_b64_tr_b16 v[82:83], v14 offset:25600
    v_mfma_f32_16x16x32_bf16 v[128:131], v[84:87], v[40:43], v[128:131]
    v_lshlrev_b32 v229, 16, v224
    v_mfma_f32_16x16x32_bf16 v[132:135], v[84:87], v[44:47], v[132:135]
    v_and_b32 v220, 0xffff0000, v220
    v_mfma_f32_16x16x32_bf16 v[136:139], v[84:87], v[48:51], v[136:139]
    ds_read_b64_tr_b16 v[84:85], v15 offset:8192
    v_mfma_f32_16x16x32_bf16 v[200:203], v[88:91], v[48:51], v[200:203]
    ds_read_b64_tr_b16 v[86:87], v15 offset:9216
    v_mfma_f32_16x16x32_bf16 v[196:199], v[88:91], v[44:47], v[196:199]
    v_and_b32 v224, 0xffff0000, v224
    v_mfma_f32_16x16x32_bf16 v[192:195], v[88:91], v[40:43], v[192:195]
    v_mul_f32 v228, v228, v229
    v_mfma_f32_16x16x32_bf16 v[188:191], v[88:91], v[36:39], v[188:191]
    ds_read_b64_tr_b16 v[88:89], v15 offset:24576
    v_mfma_f32_16x16x32_bf16 v[140:143], v[52:55], v[36:39], v[140:143]
    ds_read_b64_tr_b16 v[90:91], v15 offset:25600
    v_mfma_f32_16x16x32_bf16 v[144:147], v[52:55], v[40:43], v[144:147]
    v_mul_f32 v229, v220, v224
    v_mfma_f32_16x16x32_bf16 v[148:151], v[52:55], v[44:47], v[148:151]
    v_cvt_pk_bf16_f32 v244, v228, v229
    v_mfma_f32_16x16x32_bf16 v[152:155], v[52:55], v[48:51], v[152:155]
    v_lshlrev_b32 v228, 16, v221
    v_mfma_f32_16x16x32_bf16 v[216:219], v[56:59], v[48:51], v[216:219]
    v_lshlrev_b32 v229, 16, v225
    v_mfma_f32_16x16x32_bf16 v[212:215], v[56:59], v[44:47], v[212:215]
    v_and_b32 v221, 0xffff0000, v221
    v_mfma_f32_16x16x32_bf16 v[208:211], v[56:59], v[40:43], v[208:211]
    v_and_b32 v225, 0xffff0000, v225
    v_mfma_f32_16x16x32_bf16 v[204:207], v[56:59], v[36:39], v[204:207]
    v_mul_f32 v228, v228, v229
    s_waitcnt lgkmcnt(13)
    v_mfma_f32_16x16x32_bf16 v[92:95], v[60:63], v[20:23], v[92:95]
    ds_read_b64_tr_b16 v[52:53], v16 offset:0
    s_waitcnt lgkmcnt(11)
    v_mfma_f32_16x16x32_bf16 v[96:99], v[60:63], v[24:27], v[96:99]
    ds_read_b64_tr_b16 v[54:55], v16 offset:1024
    s_waitcnt lgkmcnt(11)
    v_mfma_f32_16x16x32_bf16 v[100:103], v[60:63], v[28:31], v[100:103]
    ds_read_b64_tr_b16 v[56:57], v16 offset:16384
    s_waitcnt lgkmcnt(9)
    v_mfma_f32_16x16x32_bf16 v[104:107], v[60:63], v[32:35], v[104:107]
    ds_read_b64_tr_b16 v[58:59], v16 offset:17408
    v_mfma_f32_16x16x32_bf16 v[168:171], v[64:67], v[32:35], v[168:171]
    ds_read_b64_tr_b16 v[60:61], v17 offset:0
    v_mfma_f32_16x16x32_bf16 v[164:167], v[64:67], v[28:31], v[164:167]
    ds_read_b64_tr_b16 v[62:63], v17 offset:1024
    v_mfma_f32_16x16x32_bf16 v[160:163], v[64:67], v[24:27], v[160:163]
    ds_read_b128 v[36:39], v9 offset:16384
    v_mfma_f32_16x16x32_bf16 v[156:159], v[64:67], v[20:23], v[156:159]
    ds_read_b64_tr_b16 v[64:65], v17 offset:16384
    v_mfma_f32_16x16x32_bf16 v[108:111], v[68:71], v[20:23], v[108:111]
    ds_read_b64_tr_b16 v[66:67], v17 offset:17408
    v_mfma_f32_16x16x32_bf16 v[112:115], v[68:71], v[24:27], v[112:115]
    ds_read_b128 v[40:43], v9 offset:18432
    v_mfma_f32_16x16x32_bf16 v[116:119], v[68:71], v[28:31], v[116:119]
    ds_read_b128 v[44:47], v9 offset:20480
    v_mfma_f32_16x16x32_bf16 v[120:123], v[68:71], v[32:35], v[120:123]
    ds_read_b64_tr_b16 v[68:69], v16 offset:8192
    v_mfma_f32_16x16x32_bf16 v[184:187], v[72:75], v[32:35], v[184:187]
    ds_read_b64_tr_b16 v[70:71], v16 offset:9216
    v_mfma_f32_16x16x32_bf16 v[180:183], v[72:75], v[28:31], v[180:183]
    ds_read_b128 v[48:51], v9 offset:22528
    v_mfma_f32_16x16x32_bf16 v[176:179], v[72:75], v[24:27], v[176:179]
    v_mul_f32 v229, v221, v225
    v_mfma_f32_16x16x32_bf16 v[172:175], v[72:75], v[20:23], v[172:175]
    ds_read_b64_tr_b16 v[72:73], v16 offset:24576
    s_waitcnt lgkmcnt(8)
    v_mfma_f32_16x16x32_bf16 v[92:95], v[76:79], v[36:39], v[92:95]
    ds_read_b64_tr_b16 v[74:75], v16 offset:25600
    s_waitcnt lgkmcnt(6)
    v_mfma_f32_16x16x32_bf16 v[96:99], v[76:79], v[40:43], v[96:99]
    v_cvt_pk_bf16_f32 v245, v228, v229
    s_waitcnt lgkmcnt(5)
    v_mfma_f32_16x16x32_bf16 v[100:103], v[76:79], v[44:47], v[100:103]
    v_lshlrev_b32 v228, 16, v222
    s_waitcnt lgkmcnt(2)
    v_mfma_f32_16x16x32_bf16 v[104:107], v[76:79], v[48:51], v[104:107]
    ds_read_b64_tr_b16 v[76:77], v17 offset:8192
    v_mfma_f32_16x16x32_bf16 v[168:171], v[80:83], v[48:51], v[168:171]
    ds_read_b64_tr_b16 v[78:79], v17 offset:9216
    v_mfma_f32_16x16x32_bf16 v[164:167], v[80:83], v[44:47], v[164:167]
    v_lshlrev_b32 v229, 16, v226
    v_mfma_f32_16x16x32_bf16 v[160:163], v[80:83], v[40:43], v[160:163]
    v_and_b32 v222, 0xffff0000, v222
    v_mfma_f32_16x16x32_bf16 v[156:159], v[80:83], v[36:39], v[156:159]
    ds_read_b64_tr_b16 v[80:81], v17 offset:24576
    v_mfma_f32_16x16x32_bf16 v[108:111], v[84:87], v[36:39], v[108:111]
    ds_read_b64_tr_b16 v[82:83], v17 offset:25600
    v_mfma_f32_16x16x32_bf16 v[112:115], v[84:87], v[40:43], v[112:115]
    v_and_b32 v226, 0xffff0000, v226
    v_mfma_f32_16x16x32_bf16 v[116:119], v[84:87], v[44:47], v[116:119]
    v_mul_f32 v228, v228, v229
    v_mfma_f32_16x16x32_bf16 v[120:123], v[84:87], v[48:51], v[120:123]
    v_mul_f32 v229, v222, v226
    v_mfma_f32_16x16x32_bf16 v[184:187], v[88:91], v[48:51], v[184:187]
    v_cvt_pk_bf16_f32 v246, v228, v229
    v_mfma_f32_16x16x32_bf16 v[180:183], v[88:91], v[44:47], v[180:183]
    v_lshlrev_b32 v228, 16, v223
    v_mfma_f32_16x16x32_bf16 v[176:179], v[88:91], v[40:43], v[176:179]
    v_lshlrev_b32 v229, 16, v227
    v_mfma_f32_16x16x32_bf16 v[172:175], v[88:91], v[36:39], v[172:175]
    v_and_b32 v223, 0xffff0000, v223
    s_waitcnt lgkmcnt(0)
    s_barrier
    ds_read_b32 v250, v235 offset:65508
    v_mfma_f32_16x16x32_bf16 v[124:127], v[52:55], v[20:23], v[124:127]
    v_and_b32 v227, 0xffff0000, v227
    v_mfma_f32_16x16x32_bf16 v[128:131], v[52:55], v[24:27], v[128:131]
    v_mul_f32 v228, v228, v229
    v_mfma_f32_16x16x32_bf16 v[132:135], v[52:55], v[28:31], v[132:135]
    v_mul_f32 v229, v223, v227
    v_mfma_f32_16x16x32_bf16 v[136:139], v[52:55], v[32:35], v[136:139]
    v_cvt_pk_bf16_f32 v247, v228, v229
    v_mfma_f32_16x16x32_bf16 v[200:203], v[56:59], v[32:35], v[200:203]
    v_mul_f32 v92, v92, v156
    v_mul_f32 v93, v93, v157
    v_mfma_f32_16x16x32_bf16 v[196:199], v[56:59], v[28:31], v[196:199]
    v_mul_f32 v94, v94, v158
    v_mul_f32 v95, v95, v159
    v_mfma_f32_16x16x32_bf16 v[192:195], v[56:59], v[24:27], v[192:195]
    v_mul_f32 v108, v108, v172
    v_mul_f32 v109, v109, v173
    v_mfma_f32_16x16x32_bf16 v[188:191], v[56:59], v[20:23], v[188:191]
    v_mul_f32 v110, v110, v174
    v_mul_f32 v111, v111, v175
    v_mfma_f32_16x16x32_bf16 v[140:143], v[60:63], v[20:23], v[140:143]
    v_cvt_pk_bf16_f32 v156, v92, v93
    v_cvt_pk_bf16_f32 v157, v94, v95
    v_mfma_f32_16x16x32_bf16 v[144:147], v[60:63], v[24:27], v[144:147]
    v_cvt_pk_bf16_f32 v158, v108, v109
    v_cvt_pk_bf16_f32 v159, v110, v111
    v_mfma_f32_16x16x32_bf16 v[148:151], v[60:63], v[28:31], v[148:151]
    buffer_store_dwordx4 v[156:159], v18, s[64:67], s34 offen offset:0 sc1
    v_mul_f32 v96, v96, v160
    v_mfma_f32_16x16x32_bf16 v[152:155], v[60:63], v[32:35], v[152:155]
    v_mul_f32 v97, v97, v161
    v_mul_f32 v98, v98, v162
    v_mfma_f32_16x16x32_bf16 v[216:219], v[64:67], v[32:35], v[216:219]
    v_mul_f32 v99, v99, v163
    v_mul_f32 v112, v112, v176
    v_mfma_f32_16x16x32_bf16 v[212:215], v[64:67], v[28:31], v[212:215]
    v_mul_f32 v113, v113, v177
    v_mul_f32 v114, v114, v178
    v_mfma_f32_16x16x32_bf16 v[208:211], v[64:67], v[24:27], v[208:211]
    v_mul_f32 v115, v115, v179
    v_cvt_pk_bf16_f32 v160, v96, v97
    v_mfma_f32_16x16x32_bf16 v[204:207], v[64:67], v[20:23], v[204:207]
    v_cvt_pk_bf16_f32 v161, v98, v99
    v_cvt_pk_bf16_f32 v162, v112, v113
    v_mfma_f32_16x16x32_bf16 v[124:127], v[68:71], v[36:39], v[124:127]
    v_cvt_pk_bf16_f32 v163, v114, v115
    buffer_store_dwordx4 v[160:163], v18, s[64:67], s34 offen offset:256 sc1
    v_mfma_f32_16x16x32_bf16 v[128:131], v[68:71], v[40:43], v[128:131]
    v_mul_f32 v100, v100, v164
    v_mul_f32 v101, v101, v165
    v_mfma_f32_16x16x32_bf16 v[132:135], v[68:71], v[44:47], v[132:135]
    v_mul_f32 v102, v102, v166
    v_mul_f32 v103, v103, v167
    v_mfma_f32_16x16x32_bf16 v[136:139], v[68:71], v[48:51], v[136:139]
    v_mul_f32 v116, v116, v180
    v_mul_f32 v117, v117, v181
    v_mfma_f32_16x16x32_bf16 v[200:203], v[72:75], v[48:51], v[200:203]
    v_mul_f32 v118, v118, v182
    v_mul_f32 v119, v119, v183
    v_mfma_f32_16x16x32_bf16 v[196:199], v[72:75], v[44:47], v[196:199]
    v_cvt_pk_bf16_f32 v164, v100, v101
    v_cvt_pk_bf16_f32 v165, v102, v103
    v_mfma_f32_16x16x32_bf16 v[192:195], v[72:75], v[40:43], v[192:195]
    v_cvt_pk_bf16_f32 v166, v116, v117
    v_cvt_pk_bf16_f32 v167, v118, v119
    v_mfma_f32_16x16x32_bf16 v[188:191], v[72:75], v[36:39], v[188:191]
    buffer_store_dwordx4 v[164:167], v18, s[64:67], s10 offen offset:0 sc1
    v_mul_f32 v104, v104, v168
    v_mfma_f32_16x16x32_bf16 v[140:143], v[76:79], v[36:39], v[140:143]
    v_mul_f32 v105, v105, v169
    v_mul_f32 v106, v106, v170
    v_mfma_f32_16x16x32_bf16 v[144:147], v[76:79], v[40:43], v[144:147]
    v_mul_f32 v107, v107, v171
    v_mul_f32 v120, v120, v184
    v_mfma_f32_16x16x32_bf16 v[148:151], v[76:79], v[44:47], v[148:151]
    v_mul_f32 v121, v121, v185
    v_mul_f32 v122, v122, v186
    v_mfma_f32_16x16x32_bf16 v[152:155], v[76:79], v[48:51], v[152:155]
    v_mul_f32 v123, v123, v187
    v_cvt_pk_bf16_f32 v168, v104, v105
    v_mfma_f32_16x16x32_bf16 v[216:219], v[80:83], v[48:51], v[216:219]
    v_cvt_pk_bf16_f32 v169, v106, v107
    v_cvt_pk_bf16_f32 v170, v120, v121
    v_mfma_f32_16x16x32_bf16 v[212:215], v[80:83], v[44:47], v[212:215]
    v_cvt_pk_bf16_f32 v171, v122, v123
    buffer_store_dwordx4 v[168:171], v18, s[64:67], s10 offen offset:256 sc1
    v_mfma_f32_16x16x32_bf16 v[208:211], v[80:83], v[40:43], v[208:211]
    v_mfma_f32_16x16x32_bf16 v[204:207], v[80:83], v[36:39], v[204:207]
    v_mul_f32 v124, v124, v188
    v_mul_f32 v125, v125, v189
    v_mul_f32 v126, v126, v190
    v_mul_f32 v127, v127, v191
    s_nop 3
    v_mul_f32 v140, v140, v204
    v_mul_f32 v141, v141, v205
    v_mul_f32 v142, v142, v206
    v_mul_f32 v143, v143, v207
    v_cvt_pk_bf16_f32 v188, v124, v125
    v_cvt_pk_bf16_f32 v189, v126, v127
    v_cvt_pk_bf16_f32 v190, v140, v141
    v_cvt_pk_bf16_f32 v191, v142, v143
    buffer_store_dwordx4 v[188:191], v18, s[64:67], s34 offen offset:2048 sc1
    v_mul_f32 v128, v128, v192
    v_mul_f32 v129, v129, v193
    v_mul_f32 v130, v130, v194
    v_mul_f32 v131, v131, v195
    v_mul_f32 v144, v144, v208
    v_mul_f32 v145, v145, v209
    v_mul_f32 v146, v146, v210
    v_mul_f32 v147, v147, v211
    v_cvt_pk_bf16_f32 v192, v128, v129
    v_cvt_pk_bf16_f32 v193, v130, v131
    v_cvt_pk_bf16_f32 v194, v144, v145
    v_cvt_pk_bf16_f32 v195, v146, v147
    buffer_store_dwordx4 v[192:195], v18, s[64:67], s34 offen offset:2304 sc1
    v_mul_f32 v132, v132, v196
    v_mul_f32 v133, v133, v197
    v_mul_f32 v134, v134, v198
    v_mul_f32 v135, v135, v199
    v_mul_f32 v148, v148, v212
    v_mul_f32 v149, v149, v213
    v_mul_f32 v150, v150, v214
    v_mul_f32 v151, v151, v215
    v_cvt_pk_bf16_f32 v196, v132, v133
    v_cvt_pk_bf16_f32 v197, v134, v135
    v_cvt_pk_bf16_f32 v198, v148, v149
    v_cvt_pk_bf16_f32 v199, v150, v151
    buffer_store_dwordx4 v[196:199], v18, s[64:67], s10 offen offset:2048 sc1
    v_mul_f32 v136, v136, v200
    v_mul_f32 v137, v137, v201
    v_mul_f32 v138, v138, v202
    v_mul_f32 v139, v139, v203
    v_mul_f32 v152, v152, v216
    v_mul_f32 v153, v153, v217
    v_mul_f32 v154, v154, v218
    v_mul_f32 v155, v155, v219
    v_cvt_pk_bf16_f32 v200, v136, v137
    v_cvt_pk_bf16_f32 v201, v138, v139
    v_cvt_pk_bf16_f32 v202, v152, v153
    v_cvt_pk_bf16_f32 v203, v154, v155
    buffer_store_dwordx4 v[200:203], v18, s[64:67], s10 offen offset:2304 sc1
    s_waitcnt lgkmcnt(0)
    v_readfirstlane_b32 s76, v250
    v_mov_b32 v6, 1
    v_mov_b32 v7, 65408
    s_setprio 0
L_help:
    s_lshl_b32 s13, s40, 4
    s_add_u32 s13, s13, s90
    buffer_load_dwordx4 v[176:179], v241, s[68:71], s13 offen
    s_add_u32 s13, s13, 8192
    buffer_load_dwordx4 v[180:183], v241, s[68:71], s13 offen
    s_add_u32 s13, s13, 8192
    buffer_load_dwordx4 v[184:187], v241, s[68:71], s13 offen
    s_add_u32 s13, s13, 8192
    buffer_load_dwordx4 v[188:191], v241, s[68:71], s13 offen
    s_add_u32 s13, s13, 8192
    buffer_load_dwordx4 v[192:195], v241, s[68:71], s13 offen
    s_add_u32 s13, s13, 8192
    buffer_load_dwordx4 v[196:199], v241, s[68:71], s13 offen
    s_add_u32 s13, s13, 8192
    buffer_load_dwordx4 v[200:203], v241, s[68:71], s13 offen
    s_add_u32 s13, s13, 8192
    buffer_load_dwordx4 v[204:207], v241, s[68:71], s13 offen
    s_waitcnt vmcnt(8)
    s_mov_b64 exec, 1
    ds_write_b32 v243, v6 offset:0
    s_mov_b64 exec, -1
    s_cmp_lg_u32 s3, 0
    s_cbranch_scc1 L_hdma
    s_cmp_lg_u32 s77, 0
    s_cbranch_scc1 L_hdma
    v_and_b32 v2, 3, v1
    v_lshl_add_u32 v2, v2, 2, v7
    ds_read_b32 v3, v2
    s_waitcnt lgkmcnt(0)
    v_cmp_eq_u32 vcc, 0, v3
    s_nop 0
    s_cmp_eq_u64 vcc, 0
    s_cbranch_scc1 L_pub0
    s_lshl_b32 s13, s41, 4
    s_add_u32 s13, s13, s90
    buffer_load_dwordx4 v[144:147], v241, s[68:71], s13 offen
    s_add_u32 s13, s13, 8192
    buffer_load_dwordx4 v[148:151], v241, s[68:71], s13 offen
    ds_read_b32 v3, v2
    s_waitcnt lgkmcnt(0)
    v_cmp_eq_u32 vcc, 0, v3
    s_nop 0
    s_cmp_eq_u64 vcc, 0
    s_cbranch_scc1 L_pub1
    s_add_u32 s13, s13, 8192
    buffer_load_dwordx4 v[152:155], v241, s[68:71], s13 offen
    s_add_u32 s13, s13, 8192
    buffer_load_dwordx4 v[156:159], v241, s[68:71], s13 offen
    ds_read_b32 v3, v2
    s_waitcnt lgkmcnt(0)
    v_cmp_eq_u32 vcc, 0, v3
    s_nop 0
    s_cmp_eq_u64 vcc, 0
    s_cbranch_scc1 L_pub2
    s_add_u32 s13, s13, 8192
    buffer_load_dwordx4 v[160:163], v241, s[68:71], s13 offen
    s_add_u32 s13, s13, 8192
    buffer_load_dwordx4 v[164:167], v241, s[68:71], s13 offen
    ds_read_b32 v3, v2
    s_waitcnt lgkmcnt(0)
    v_cmp_eq_u32 vcc, 0, v3
    s_nop 0
    s_cmp_eq_u64 vcc, 0
    s_cbranch_scc1 L_pub3
    s_add_u32 s13, s13, 8192
    buffer_load_dwordx4 v[168:171], v241, s[68:71], s13 offen
    s_add_u32 s13, s13, 8192
    buffer_load_dwordx4 v[172:175], v241, s[68:71], s13 offen
    ds_read_b32 v3, v2
    s_waitcnt lgkmcnt(0)
    v_cmp_eq_u32 vcc, 0, v3
    s_nop 0
    s_cmp_eq_u64 vcc, 0
    s_cbranch_scc1 L_pub4
    s_add_u32 m0, s91, 131072
    s_lshl_b32 s13, s38, 4
    s_add_u32 s13, s13, s90
    buffer_load_dwordx4 v241, s[68:71], s13 offen lds
    s_add_u32 m0, s91, 132096
    s_add_u32 s13, s13, 8192
    buffer_load_dwordx4 v241, s[68:71], s13 offen lds
    ds_read_b32 v3, v2
    s_waitcnt lgkmcnt(0)
    v_cmp_eq_u32 vcc, 0, v3
    s_nop 0
    s_cmp_eq_u64 vcc, 0
    s_cbranch_scc1 L_pub5
    s_add_u32 m0, s91, 133120
    s_add_u32 s13, s13, 8192
    buffer_load_dwordx4 v241, s[68:71], s13 offen lds
    s_add_u32 m0, s91, 134144
    s_add_u32 s13, s13, 8192
    buffer_load_dwordx4 v241, s[68:71], s13 offen lds
Llw_43:
    ds_read_b32 v3, v2 offset:0
    s_add_u32 s78, s78, 1
    s_waitcnt lgkmcnt(0)
    v_cmp_eq_u32 vcc, 0, v3
    s_nop 0
    s_cmp_eq_u64 vcc, 0
    s_cbranch_scc1 Llok_44
    s_cmp_lt_u32 s78, 32000000
    s_cbranch_scc1 Llw_43
Llok_44:
L_pub6:
    v_mov_b32 v250, 0
    v_mov_b32 v251, s76
    s_mov_b64 exec, 1
    buffer_store_dword v251, v250, s[64:67], s35 offen sc1
    s_mov_b64 exec, -1
    s_branch L_seg6
L_pub5:
    v_mov_b32 v250, 0
    v_mov_b32 v251, s76
    s_mov_b64 exec, 1
    buffer_store_dword v251, v250, s[64:67], s35 offen sc1
    s_mov_b64 exec, -1
    s_branch L_seg5
L_pub4:
    v_mov_b32 v250, 0
    v_mov_b32 v251, s76
    s_mov_b64 exec, 1
    buffer_store_dword v251, v250, s[64:67], s35 offen sc1
    s_mov_b64 exec, -1
    s_branch L_seg4
L_pub3:
    v_mov_b32 v250, 0
    v_mov_b32 v251, s76
    s_mov_b64 exec, 1
    buffer_store_dword v251, v250, s[64:67], s35 offen sc1
    s_mov_b64 exec, -1
    s_branch L_seg3
L_pub2:
    v_mov_b32 v250, 0
    v_mov_b32 v251, s76
    s_mov_b64 exec, 1
    buffer_store_dword v251, v250, s[64:67], s35 offen sc1
    s_mov_b64 exec, -1
    s_branch L_seg2
L_pub1:
    v_mov_b32 v250, 0
    v_mov_b32 v251, s76
    s_mov_b64 exec, 1
    buffer_store_dword v251, v250, s[64:67], s35 offen sc1
    s_mov_b64 exec, -1
    s_branch L_seg1
L_pub0:
    v_mov_b32 v250, 0
    v_mov_b32 v251, s76
    s_mov_b64 exec, 1
    buffer_store_dword v251, v250, s[64:67], s35 offen sc1
    s_mov_b64 exec, -1
L_hdma:
    s_lshl_b32 s13, s41, 4
    s_add_u32 s13, s13, s90
    buffer_load_dwordx4 v[144:147], v241, s[68:71], s13 offen
    s_add_u32 s13, s13, 8192
    buffer_load_dwordx4 v[148:151], v241, s[68:71], s13 offen
L_seg1:
    s_add_u32 s13, s13, 8192
    buffer_load_dwordx4 v[152:155], v241, s[68:71], s13 offen
    s_add_u32 s13, s13, 8192
    buffer_load_dwordx4 v[156:159], v241, s[68:71], s13 offen
L_seg2:
    s_add_u32 s13, s13, 8192
    buffer_load_dwordx4 v[160:163], v241, s[68:71], s13 offen
    s_add_u32 s13, s13, 8192
    buffer_load_dwordx4 v[164:167], v241, s[68:71], s13 offen
L_seg3:
    s_add_u32 s13, s13, 8192
    buffer_load_dwordx4 v[168:171], v241, s[68:71], s13 offen
    s_add_u32 s13, s13, 8192
    buffer_load_dwordx4 v[172:175], v241, s[68:71], s13 offen
L_seg4:
    s_add_u32 m0, s91, 131072
    s_lshl_b32 s13, s38, 4
    s_add_u32 s13, s13, s90
    buffer_load_dwordx4 v241, s[68:71], s13 offen lds
    s_add_u32 m0, s91, 132096
    s_add_u32 s13, s13, 8192
    buffer_load_dwordx4 v241, s[68:71], s13 offen lds
L_seg5:
    s_add_u32 m0, s91, 133120
    s_add_u32 s13, s13, 8192
    buffer_load_dwordx4 v241, s[68:71], s13 offen lds
    s_add_u32 m0, s91, 134144
    s_add_u32 s13, s13, 8192
    buffer_load_dwordx4 v241, s[68:71], s13 offen lds
L_seg6:
    s_add_u32 m0, s91, 135168
    s_add_u32 s13, s13, 8192
    buffer_load_dwordx4 v241, s[68:71], s13 offen lds
    s_add_u32 m0, s91, 136192
    s_add_u32 s13, s13, 8192
    buffer_load_dwordx4 v241, s[68:71], s13 offen lds
    s_add_u32 m0, s91, 137216
    s_add_u32 s13, s13, 8192
    buffer_load_dwordx4 v241, s[68:71], s13 offen lds
    s_add_u32 m0, s91, 138240
    s_add_u32 s13, s13, 8192
    buffer_load_dwordx4 v241, s[68:71], s13 offen lds
    s_add_u32 m0, s91, 0
    s_lshl_b32 s13, s39, 4
    s_add_u32 s13, s13, s90
    buffer_load_dwordx4 v241, s[68:71], s13 offen lds
    s_add_u32 m0, s91, 1024
    s_add_u32 s13, s13, 8192
    buffer_load_dwordx4 v241, s[68:71], s13 offen lds
    s_add_u32 m0, s91, 2048
    s_add_u32 s13, s13, 8192
    buffer_load_dwordx4 v241, s[68:71], s13 offen lds
    s_add_u32 m0, s91, 3072
    s_add_u32 s13, s13, 8192
    buffer_load_dwordx4 v241, s[68:71], s13 offen lds
    s_add_u32 m0, s91, 4096
    s_add_u32 s13, s13, 8192
    buffer_load_dwordx4 v241, s[68:71], s13 offen lds
    s_add_u32 m0, s91, 5120
    s_add_u32 s13, s13, 8192
    buffer_load_dwordx4 v241, s[68:71], s13 offen lds
    s_add_u32 m0, s91, 6144
    s_add_u32 s13, s13, 8192
    buffer_load_dwordx4 v241, s[68:71], s13 offen lds
    s_add_u32 m0, s91, 7168
    s_add_u32 s13, s13, 8192
    buffer_load_dwordx4 v241, s[68:71], s13 offen lds
    v_mov_b32 v8, v242
    v_xor_b32 v9, 64, v242
    v_add_u32 v10, 65536, v8
    v_add_u32 v12, 131072, v8
    v_add_u32 v11, 65536, v9
    v_add_u32 v13, 131072, v9
    v_add_u32 v77, s91, v240
    s_cmp_lg_u32 s3, 1
    s_cbranch_scc1 Low_45
    s_lshr_b32 s79, s80, 1
    s_mul_i32 s79, s79, 1280
    s_add_u32 s79, s79, 13107200
    s_mov_b32 s8, s76
    s_mov_b32 s9, s76
    s_mov_b32 s12, 0
L_sp:
    s_buffer_load_dwordx16 s[16:31], s[64:67], s79 glc
L_sp1:
    s_add_u32 s12, s12, 1
    s_waitcnt lgkmcnt(0)
    s_xor_b64 s[10:11], s[16:17], s[8:9]
    s_xor_b64 s[14:15], s[18:19], s[8:9]
    s_or_b64 s[10:11], s[10:11], s[14:15]
    s_xor_b64 s[14:15], s[20:21], s[8:9]
    s_or_b64 s[10:11], s[10:11], s[14:15]
    s_xor_b64 s[14:15], s[22:23], s[8:9]
    s_or_b64 s[10:11], s[10:11], s[14:15]
    s_xor_b64 s[14:15], s[24:25], s[8:9]
    s_or_b64 s[10:11], s[10:11], s[14:15]
    s_xor_b64 s[14:15], s[26:27], s[8:9]
    s_or_b64 s[10:11], s[10:11], s[14:15]
    s_xor_b64 s[14:15], s[28:29], s[8:9]
    s_or_b64 s[10:11], s[10:11], s[14:15]
    s_cbranch_scc0 L_fnd
    s_cmp_lt_u32 s12, 64
    s_cbranch_scc1 L_sp
    v_min_u32 v252, 13, v1
    v_lshlrev_b32 v252, 2, v252
    buffer_load_dword v249, v252, s[64:67], s79 offen sc1
    s_waitcnt vmcnt(0)
Lpok_46r:
    v_cmp_ne_u32 vcc, s76, v249
    s_nop 0
    s_cmp_lg_u64 vcc, 0
    s_cbranch_scc1 Lplp_47
Lpok_46:
L_fnd:
Low_45:
    s_waitcnt vmcnt(0)
    s_barrier
    s_add_u32 s87, s84, s36
    buffer_load_dwordx4 v[80:83], v240, s[64:67], s87 offen offset:0 sc1
    buffer_load_dwordx4 v[84:87], v240, s[64:67], s87 offen offset:1024 sc1
    buffer_load_dwordx4 v[88:91], v240, s[64:67], s87 offen offset:2048 sc1
    ds_read_b64_tr_b16 v[20:21], v10 offset:0
    ds_read_b64_tr_b16 v[22:23], v10 offset:2048
    ds_read_b64_tr_b16 v[24:25], v11 offset:0
    ds_read_b64_tr_b16 v[26:27], v11 offset:2048
    ds_read_b64_tr_b16 v[28:29], v10 offset:1024
    ds_read_b64_tr_b16 v[30:31], v10 offset:3072
    ds_read_b64_tr_b16 v[32:33], v11 offset:1024
    ds_read_b64_tr_b16 v[34:35], v11 offset:3072
    v_add_u32 v76, 32768, v77
    ds_write_b128 v76, v[176:179] offset:0
    ds_write_b128 v76, v[180:183] offset:1024
    s_add_u32 s87, s84, s36
    buffer_load_dwordx4 v[92:95], v240, s[64:67], s87 offen offset:3072 sc1
    s_add_u32 s87, s84, s37
    buffer_load_dwordx4 v[96:99], v240, s[64:67], s87 offen offset:0 sc1
    buffer_load_dwordx4 v[100:103], v240, s[64:67], s87 offen offset:1024 sc1
    ds_write_b128 v76, v[184:187] offset:2048
    ds_write_b128 v76, v[188:191] offset:3072
    s_waitcnt vmcnt(5) lgkmcnt(10)
    v_mfma_f32_32x32x16_bf16 v[44:59], v[20:23], v[80:83], 0
    ds_read_b64_tr_b16 v[36:37], v10 offset:4096
    ds_read_b64_tr_b16 v[38:39], v10 offset:6144
    s_add_u32 s87, s84, s37
    buffer_load_dwordx4 v[104:107], v240, s[64:67], s87 offen offset:2048 sc1
    s_lshl_b32 s10, s81, 7
    v_lshl_add_u32 v252, v1, 2, s10
    s_lshl_b32 s10, s80, 2
    s_add_u32 s10, s10, 4096
    s_waitcnt lgkmcnt(10)
    v_mfma_f32_32x32x16_bf16 v[60:75], v[24:27], v[80:83], 0
    ds_read_b64_tr_b16 v[40:41], v11 offset:4096
    ds_read_b64_tr_b16 v[42:43], v11 offset:6144
    ds_write_b128 v76, v[192:195] offset:4096
    v_mov_b32 v2, s10
    v_cmp_lt_u32 vcc, 31, v1
    s_mov_b32 s79, 12656640
    v_lshrrev_b32 v6, 3, v1
    s_waitcnt vmcnt(5) lgkmcnt(11)
    v_mfma_f32_32x32x16_bf16 v[44:59], v[28:31], v[84:87], v[44:59]
    ds_read_b64_tr_b16 v[20:21], v10 offset:5120
    ds_read_b64_tr_b16 v[22:23], v10 offset:7168
    s_add_u32 s87, s84, s37
    buffer_load_dwordx4 v[108:111], v240, s[64:67], s87 offen offset:3072 sc1
    v_cndmask_b32 v252, v252, v2, vcc
    v_lshlrev_b32 v6, 12, v6
    v_and_b32 v3, 7, v1
    v_lshl_add_u32 v6, v3, 4, v6
    s_waitcnt lgkmcnt(11)
    v_mfma_f32_32x32x16_bf16 v[60:75], v[32:35], v[84:87], v[60:75]
    ds_read_b64_tr_b16 v[24:25], v11 offset:5120
    ds_read_b64_tr_b16 v[26:27], v11 offset:7168
    ds_write_b128 v76, v[196:199] offset:5120
    s_lshl_b32 s6, s81, 3
    s_add_u32 s6, s6, s3
    s_lshl_b32 s6, s6, 15
    s_lshl_b32 s10, s80, 7
    s_barrier
    s_waitcnt vmcnt(5) lgkmcnt(8)
    v_mfma_f32_32x32x16_bf16 v[44:59], v[36:39], v[88:91], v[44:59]
    ds_read_b64_tr_b16 v[28:29], v10 offset:32768
    ds_read_b64_tr_b16 v[30:31], v10 offset:34816
    s_add_u32 s87, s84, s38
    buffer_load_dwordx4 v[112:115], v240, s[64:67], s87 offen offset:0 sc1
    s_add_u32 s6, s6, s10
    s_add_u32 s6, s6, 10485760
    v_and_b32 v4, 31, v1
    v_lshlrev_b32 v7, 2, v4
    s_waitcnt lgkmcnt(8)
    v_mfma_f32_32x32x16_bf16 v[60:75], v[40:43], v[88:91], v[60:75]
    ds_read_b64_tr_b16 v[32:33], v11 offset:32768
    ds_read_b64_tr_b16 v[34:35], v11 offset:34816
    ds_write_b128 v76, v[200:203] offset:6144
    v_lshrrev_b32 v15, 5, v1
    v_lshlrev_b32 v5, 4, v15
    v_lshl_add_u32 v14, v4, 10, v5
    v_bfe_u32 v4, v1, 2, 2
    s_waitcnt vmcnt(5) lgkmcnt(8)
    v_mfma_f32_32x32x16_bf16 v[44:59], v[20:23], v[92:95], v[44:59]
    ds_read_b64_tr_b16 v[36:37], v10 offset:33792
    ds_read_b64_tr_b16 v[38:39], v10 offset:35840
    s_add_u32 s87, s84, s38
    buffer_load_dwordx4 v[116:119], v240, s[64:67], s87 offen offset:1024 sc1
    v_lshl_add_u32 v15, v15, 3, v4
    v_lshlrev_b32 v15, 7, v15
    v_bfe_u32 v4, v1, 4, 1
    v_lshl_add_u32 v15, v4, 5, v15
    s_waitcnt lgkmcnt(8)
    v_mfma_f32_32x32x16_bf16 v[60:75], v[24:27], v[92:95], v[60:75]
    ds_read_b64_tr_b16 v[40:41], v11 offset:33792
    ds_read_b64_tr_b16 v[42:43], v11 offset:35840
    ds_write_b128 v76, v[204:207] offset:7168
    v_and_b32 v4, 3, v1
    v_lshl_add_u32 v15, v4, 3, v15
    s_lshr_b32 s10, s3, 1
    s_lshl_b32 s10, s10, 11
    s_waitcnt vmcnt(5) lgkmcnt(8)
    v_mfma_f32_32x32x16_bf16 v[44:59], v[28:31], v[96:99], v[44:59]
    ds_read_b64_tr_b16 v[20:21], v10 offset:36864
    ds_read_b64_tr_b16 v[22:23], v10 offset:38912
    s_add_u32 s87, s84, s38
    buffer_load_dwordx4 v[120:123], v240, s[64:67], s87 offen offset:2048 sc1
    s_and_b32 s11, s3, 1
    s_lshl_b32 s11, s11, 6
    s_add_u32 s10, s10, s11
    s_add_u32 s10, s10, 155648
    s_waitcnt lgkmcnt(8)
    v_mfma_f32_32x32x16_bf16 v[60:75], v[32:35], v[96:99], v[60:75]
    ds_read_b64_tr_b16 v[24:25], v11 offset:36864
    ds_read_b64_tr_b16 v[26:27], v11 offset:38912
    v_add_u32 v15, s10, v15
    s_lshl_b32 s10, s3, 10
    s_add_u32 s10, s10, 155648
    v_add_u32 v79, s10, v240
    s_waitcnt vmcnt(5) lgkmcnt(7)
    v_mfma_f32_32x32x16_bf16 v[44:59], v[36:39], v[100:103], v[44:59]
    ds_read_b64_tr_b16 v[28:29], v10 offset:37888
    ds_read_b64_tr_b16 v[30:31], v10 offset:39936
    s_add_u32 s87, s84, s38
    buffer_load_dwordx4 v[124:127], v240, s[64:67], s87 offen offset:3072 sc1
    s_xor_b32 s10, s83, 0
    s_mul_i32 s10, s10, 6144
    s_add_u32 s10, s10, 131072
    v_add_u32 v78, s10, v240
    s_waitcnt lgkmcnt(7)
    v_mfma_f32_32x32x16_bf16 v[60:75], v[40:43], v[100:103], v[60:75]
    ds_read_b64_tr_b16 v[32:33], v11 offset:37888
    ds_read_b64_tr_b16 v[34:35], v11 offset:39936
    s_xor_b32 s10, s83, 2
    s_mul_i32 s10, s10, 6144
    s_add_u32 s10, s10, 131072
    v_add_u32 v17, s10, v240
    s_waitcnt vmcnt(5) lgkmcnt(6)
    v_mfma_f32_32x32x16_bf16 v[44:59], v[20:23], v[104:107], v[44:59]
    ds_read_b64_tr_b16 v[36:37], v12 offset:0
    ds_read_b64_tr_b16 v[38:39], v12 offset:2048
    s_add_u32 s87, s84, s39
    buffer_load_dwordx4 v[128:131], v240, s[64:67], s87 offen offset:0 sc1
    s_xor_b32 s10, s83, 0
    s_mul_i32 s10, s10, 6144
    s_add_u32 s10, s10, 2048
    v_add_u32 v18, s10, v240
    s_waitcnt lgkmcnt(6)
    v_mfma_f32_32x32x16_bf16 v[60:75], v[24:27], v[104:107], v[60:75]
    ds_read_b64_tr_b16 v[40:41], v13 offset:0
    ds_read_b64_tr_b16 v[42:43], v13 offset:2048
    s_xor_b32 s10, s83, 2
    s_mul_i32 s10, s10, 6144
    s_add_u32 s10, s10, 4096
    v_add_u32 v19, s10, v240
    s_waitcnt vmcnt(5) lgkmcnt(6)
    v_mfma_f32_32x32x16_bf16 v[44:59], v[28:31], v[108:111], v[44:59]
    ds_read_b64_tr_b16 v[20:21], v12 offset:1024
    ds_read_b64_tr_b16 v[22:23], v12 offset:3072
    s_add_u32 s87, s84, s39
    buffer_load_dwordx4 v[132:135], v240, s[64:67], s87 offen offset:1024 sc1
    s_waitcnt lgkmcnt(6)
    v_mfma_f32_32x32x16_bf16 v[60:75], v[32:35], v[108:111], v[60:75]
    ds_read_b64_tr_b16 v[24:25], v13 offset:1024
    ds_read_b64_tr_b16 v[26:27], v13 offset:3072
    s_waitcnt vmcnt(5) lgkmcnt(6)
    v_mfma_f32_32x32x16_bf16 v[44:59], v[36:39], v[112:115], v[44:59]
    ds_read_b64_tr_b16 v[28:29], v12 offset:4096
    ds_read_b64_tr_b16 v[30:31], v12 offset:6144
    s_add_u32 s87, s84, s39
    buffer_load_dwordx4 v[136:139], v240, s[64:67], s87 offen offset:2048 sc1
    s_waitcnt lgkmcnt(6)
    v_mfma_f32_32x32x16_bf16 v[60:75], v[40:43], v[112:115], v[60:75]
    ds_read_b64_tr_b16 v[32:33], v13 offset:4096
    ds_read_b64_tr_b16 v[34:35], v13 offset:6144
    s_waitcnt vmcnt(5) lgkmcnt(6)
    v_mfma_f32_32x32x16_bf16 v[44:59], v[20:23], v[116:119], v[44:59]
    ds_read_b64_tr_b16 v[36:37], v12 offset:5120
    ds_read_b64_tr_b16 v[38:39], v12 offset:7168
    s_add_u32 s87, s84, s39
    buffer_load_dwordx4 v[140:143], v240, s[64:67], s87 offen offset:3072 sc1
    s_waitcnt lgkmcnt(6)
    v_mfma_f32_32x32x16_bf16 v[60:75], v[24:27], v[116:119], v[60:75]
    ds_read_b64_tr_b16 v[40:41], v13 offset:5120
    ds_read_b64_tr_b16 v[42:43], v13 offset:7168
    s_barrier
    s_waitcnt vmcnt(5) lgkmcnt(6)
    v_mfma_f32_32x32x16_bf16 v[44:59], v[28:31], v[120:123], v[44:59]
    ds_read_b64_tr_b16 v[20:21], v8 offset:0
    ds_read_b64_tr_b16 v[22:23], v8 offset:2048
    s_add_u32 s87, s84, s40
    buffer_load_dwordx4 v[80:83], v240, s[64:67], s87 offen offset:0 sc1
    s_waitcnt lgkmcnt(6)
    v_mfma_f32_32x32x16_bf16 v[60:75], v[32:35], v[120:123], v[60:75]
    ds_read_b64_tr_b16 v[24:25], v9 offset:0
    ds_read_b64_tr_b16 v[26:27], v9 offset:2048
    v_add_u32 v76, 65536, v77
    ds_write_b128 v76, v[144:147] offset:0
    s_waitcnt vmcnt(5) lgkmcnt(7)
    v_mfma_f32_32x32x16_bf16 v[44:59], v[36:39], v[124:127], v[44:59]
    ds_read_b64_tr_b16 v[28:29], v8 offset:1024
    ds_read_b64_tr_b16 v[30:31], v8 offset:3072
    s_add_u32 s87, s84, s40
    buffer_load_dwordx4 v[84:87], v240, s[64:67], s87 offen offset:1024 sc1
    s_waitcnt lgkmcnt(7)
    v_mfma_f32_32x32x16_bf16 v[60:75], v[40:43], v[124:127], v[60:75]
    ds_read_b64_tr_b16 v[32:33], v9 offset:1024
    ds_read_b64_tr_b16 v[34:35], v9 offset:3072
    ds_write_b128 v76, v[148:151] offset:1024
    s_waitcnt vmcnt(5) lgkmcnt(8)
    v_mfma_f32_32x32x16_bf16 v[44:59], v[20:23], v[128:131], v[44:59]
    ds_read_b64_tr_b16 v[36:37], v8 offset:4096
    ds_read_b64_tr_b16 v[38:39], v8 offset:6144
    s_add_u32 s87, s84, s40
    buffer_load_dwordx4 v[88:91], v240, s[64:67], s87 offen offset:2048 sc1
    s_waitcnt lgkmcnt(8)
    v_mfma_f32_32x32x16_bf16 v[60:75], v[24:27], v[128:131], v[60:75]
    ds_read_b64_tr_b16 v[40:41], v9 offset:4096
    ds_read_b64_tr_b16 v[42:43], v9 offset:6144
    ds_write_b128 v76, v[152:155] offset:2048
    s_waitcnt vmcnt(5) lgkmcnt(8)
    v_mfma_f32_32x32x16_bf16 v[44:59], v[28:31], v[132:135], v[44:59]
    ds_read_b64_tr_b16 v[20:21], v8 offset:5120
    ds_read_b64_tr_b16 v[22:23], v8 offset:7168
    s_add_u32 s87, s84, s40
    buffer_load_dwordx4 v[92:95], v240, s[64:67], s87 offen offset:3072 sc1
    s_waitcnt lgkmcnt(8)
    v_mfma_f32_32x32x16_bf16 v[60:75], v[32:35], v[132:135], v[60:75]
    ds_read_b64_tr_b16 v[24:25], v9 offset:5120
    ds_read_b64_tr_b16 v[26:27], v9 offset:7168
    ds_write_b128 v76, v[156:159] offset:3072
    s_waitcnt vmcnt(5) lgkmcnt(8)
    v_mfma_f32_32x32x16_bf16 v[44:59], v[36:39], v[136:139], v[44:59]
    ds_read_b64_tr_b16 v[28:29], v8 offset:32768
    ds_read_b64_tr_b16 v[30:31], v8 offset:34816
    s_add_u32 s87, s84, s41
    buffer_load_dwordx4 v[96:99], v240, s[64:67], s87 offen offset:0 sc1
    s_waitcnt lgkmcnt(8)
    v_mfma_f32_32x32x16_bf16 v[60:75], v[40:43], v[136:139], v[60:75]
    ds_read_b64_tr_b16 v[32:33], v9 offset:32768
    ds_read_b64_tr_b16 v[34:35], v9 offset:34816
    ds_write_b128 v76, v[160:163] offset:4096
    s_waitcnt vmcnt(5) lgkmcnt(8)
    v_mfma_f32_32x32x16_bf16 v[44:59], v[20:23], v[140:143], v[44:59]
    ds_read_b64_tr_b16 v[36:37], v8 offset:33792
    ds_read_b64_tr_b16 v[38:39], v8 offset:35840
    s_add_u32 s87, s84, s41
    buffer_load_dwordx4 v[100:103], v240, s[64:67], s87 offen offset:1024 sc1
    s_waitcnt lgkmcnt(8)
    v_mfma_f32_32x32x16_bf16 v[60:75], v[24:27], v[140:143], v[60:75]
    ds_read_b64_tr_b16 v[40:41], v9 offset:33792
    ds_read_b64_tr_b16 v[42:43], v9 offset:35840
    buffer_load_dword v249, v252, s[64:67], s79 offen sc1
    ds_write_b128 v76, v[164:167] offset:5120
    s_waitcnt vmcnt(6) lgkmcnt(8)
    v_mfma_f32_32x32x16_bf16 v[44:59], v[28:31], v[80:83], v[44:59]
    ds_read_b64_tr_b16 v[20:21], v8 offset:36864
    ds_read_b64_tr_b16 v[22:23], v8 offset:38912
    s_add_u32 s87, s84, s41
    buffer_load_dwordx4 v[104:107], v240, s[64:67], s87 offen offset:2048 sc1
    s_waitcnt lgkmcnt(8)
    v_mfma_f32_32x32x16_bf16 v[60:75], v[32:35], v[80:83], v[60:75]
    ds_read_b64_tr_b16 v[24:25], v9 offset:36864
    ds_read_b64_tr_b16 v[26:27], v9 offset:38912
    ds_write_b128 v76, v[168:171] offset:6144
    s_waitcnt vmcnt(6) lgkmcnt(8)
    v_mfma_f32_32x32x16_bf16 v[44:59], v[36:39], v[84:87], v[44:59]
    ds_read_b64_tr_b16 v[28:29], v8 offset:37888
    ds_read_b64_tr_b16 v[30:31], v8 offset:39936
    s_add_u32 s87, s84, s41
    buffer_load_dwordx4 v[108:111], v240, s[64:67], s87 offen offset:3072 sc1
    s_waitcnt lgkmcnt(8)
    v_mfma_f32_32x32x16_bf16 v[60:75], v[40:43], v[84:87], v[60:75]
    ds_read_b64_tr_b16 v[32:33], v9 offset:37888
    ds_read_b64_tr_b16 v[34:35], v9 offset:39936
    ds_write_b128 v76, v[172:175] offset:7168
    s_waitcnt lgkmcnt(0)
    s_barrier
    s_waitcnt vmcnt(6)
    v_mfma_f32_32x32x16_bf16 v[44:59], v[20:23], v[88:91], v[44:59]
    ds_read_b64_tr_b16 v[36:37], v10 offset:0
    ds_read_b64_tr_b16 v[38:39], v10 offset:2048
    s_add_u32 s87, s84, s42
    buffer_load_dwordx4 v[112:115], v240, s[64:67], s87 offen offset:0 sc1
    v_mfma_f32_32x32x16_bf16 v[60:75], v[24:27], v[88:91], v[60:75]
    ds_read_b64_tr_b16 v[40:41], v11 offset:0
    ds_read_b64_tr_b16 v[42:43], v11 offset:2048
    s_waitcnt vmcnt(6)
    v_mfma_f32_32x32x16_bf16 v[44:59], v[28:31], v[92:95], v[44:59]
    ds_read_b64_tr_b16 v[20:21], v10 offset:1024
    ds_read_b64_tr_b16 v[22:23], v10 offset:3072
    s_add_u32 s87, s84, s42
    buffer_load_dwordx4 v[116:119], v240, s[64:67], s87 offen offset:1024 sc1
    v_lshlrev_b32 v188, 16, v244
    v_and_b32 v189, 0xffff0000, v244
    v_lshlrev_b32 v190, 16, v245
    v_and_b32 v191, 0xffff0000, v245
    v_mfma_f32_32x32x16_bf16 v[60:75], v[32:35], v[92:95], v[60:75]
    ds_read_b64_tr_b16 v[24:25], v11 offset:1024
    ds_read_b64_tr_b16 v[26:27], v11 offset:3072
    v_lshlrev_b32 v192, 16, v246
    v_and_b32 v193, 0xffff0000, v246
    v_lshlrev_b32 v194, 16, v247
    v_and_b32 v195, 0xffff0000, v247
    s_waitcnt vmcnt(6) lgkmcnt(6)
    v_mfma_f32_32x32x16_bf16 v[44:59], v[36:39], v[96:99], v[44:59]
    ds_read_b64_tr_b16 v[28:29], v10 offset:4096
    ds_read_b64_tr_b16 v[30:31], v10 offset:6144
    s_add_u32 s87, s84, s42
    buffer_load_dwordx4 v[120:123], v240, s[64:67], s87 offen offset:2048 sc1
    s_waitcnt lgkmcnt(6)
    v_mfma_f32_32x32x16_bf16 v[60:75], v[40:43], v[96:99], v[60:75]
    ds_read_b64_tr_b16 v[32:33], v11 offset:4096
    ds_read_b64_tr_b16 v[34:35], v11 offset:6144
    s_waitcnt vmcnt(6) lgkmcnt(6)
    v_mfma_f32_32x32x16_bf16 v[44:59], v[20:23], v[100:103], v[44:59]
    ds_read_b64_tr_b16 v[36:37], v10 offset:5120
    ds_read_b64_tr_b16 v[38:39], v10 offset:7168
    s_add_u32 s87, s84, s42
    buffer_load_dwordx4 v[124:127], v240, s[64:67], s87 offen offset:3072 sc1
    s_waitcnt lgkmcnt(6)
    v_mfma_f32_32x32x16_bf16 v[60:75], v[24:27], v[100:103], v[60:75]
    ds_read_b64_tr_b16 v[40:41], v11 offset:5120
    ds_read_b64_tr_b16 v[42:43], v11 offset:7168
    s_barrier
    s_waitcnt vmcnt(5) lgkmcnt(6)
    v_mfma_f32_32x32x16_bf16 v[44:59], v[28:31], v[104:107], v[44:59]
    ds_read_b64_tr_b16 v[20:21], v10 offset:32768
    ds_read_b64_tr_b16 v[22:23], v10 offset:34816
    s_waitcnt vmcnt(6)
Lpok_48r:
    v_cmp_ne_u32 vcc, s76, v249
    s_nop 0
    s_cmp_lg_u64 vcc, 0
    s_cbranch_scc1 Lplp_49
Lpok_48:
    buffer_load_dwordx4 v[180:183], v6, s[64:67], s6 offen sc1
    buffer_load_dword v16, v7, s[64:67], s51 offen sc1
    s_waitcnt lgkmcnt(6)
    v_mfma_f32_32x32x16_bf16 v[60:75], v[32:35], v[104:107], v[60:75]
    ds_read_b64_tr_b16 v[24:25], v11 offset:32768
    ds_read_b64_tr_b16 v[26:27], v11 offset:34816
    s_waitcnt vmcnt(6) lgkmcnt(6)
    v_mfma_f32_32x32x16_bf16 v[44:59], v[36:39], v[108:111], v[44:59]
    ds_read_b64_tr_b16 v[28:29], v10 offset:33792
    ds_read_b64_tr_b16 v[30:31], v10 offset:35840
    s_waitcnt lgkmcnt(6)
    v_mfma_f32_32x32x16_bf16 v[60:75], v[40:43], v[108:111], v[60:75]
    ds_read_b64_tr_b16 v[32:33], v11 offset:33792
    ds_read_b64_tr_b16 v[34:35], v11 offset:35840
    s_waitcnt vmcnt(5) lgkmcnt(6)
    v_mfma_f32_32x32x16_bf16 v[44:59], v[20:23], v[112:115], v[44:59]
    ds_read_b64_tr_b16 v[36:37], v10 offset:36864
    ds_read_b64_tr_b16 v[38:39], v10 offset:38912
    s_waitcnt lgkmcnt(6)
    v_mfma_f32_32x32x16_bf16 v[60:75], v[24:27], v[112:115], v[60:75]
    ds_read_b64_tr_b16 v[40:41], v11 offset:36864
    ds_read_b64_tr_b16 v[42:43], v11 offset:38912
    s_waitcnt vmcnt(4) lgkmcnt(6)
    v_mfma_f32_32x32x16_bf16 v[44:59], v[28:31], v[116:119], v[44:59]
    ds_read_b64_tr_b16 v[20:21], v10 offset:37888
    ds_read_b64_tr_b16 v[22:23], v10 offset:39936
    s_waitcnt lgkmcnt(6)
    v_mfma_f32_32x32x16_bf16 v[60:75], v[32:35], v[116:119], v[60:75]
    ds_read_b64_tr_b16 v[24:25], v11 offset:37888
    ds_read_b64_tr_b16 v[26:27], v11 offset:39936
    s_waitcnt vmcnt(3) lgkmcnt(6)
    v_mfma_f32_32x32x16_bf16 v[44:59], v[36:39], v[120:123], v[44:59]
    s_waitcnt lgkmcnt(4)
    v_mfma_f32_32x32x16_bf16 v[60:75], v[40:43], v[120:123], v[60:75]
    s_waitcnt vmcnt(2) lgkmcnt(2)
    v_mfma_f32_32x32x16_bf16 v[44:59], v[20:23], v[124:127], v[44:59]
    s_waitcnt lgkmcnt(0)
    v_mfma_f32_32x32x16_bf16 v[60:75], v[24:27], v[124:127], v[60:75]
    s_waitcnt vmcnt(0)
    ds_write_b128 v79, v[180:183]
    s_nop 7
    ds_write_b128 v78, v[52:55] offset:0
    ds_write_b128 v78, v[56:59] offset:1024
    ds_write_b128 v78, v[60:63] offset:2048
    ds_write_b128 v78, v[64:67] offset:3072
    ds_write_b128 v78, v[68:71] offset:4096
    ds_write_b128 v78, v[72:75] offset:5120
    v_sub_f32 v188, v188, v44
    v_fmac_f32 v44, v16, v188
    v_sub_f32 v189, v189, v45
    v_fmac_f32 v45, v16, v189
    v_sub_f32 v190, v190, v46
    v_fmac_f32 v46, v16, v190
    v_sub_f32 v191, v191, v47
    v_fmac_f32 v47, v16, v191
    v_sub_f32 v192, v192, v48
    v_fmac_f32 v48, v16, v192
    v_sub_f32 v193, v193, v49
    v_fmac_f32 v49, v16, v193
    v_sub_f32 v194, v194, v50
    v_fmac_f32 v50, v16, v194
    v_sub_f32 v195, v195, v51
    v_fmac_f32 v51, v16, v195
    v_sub_f32 v3, 1.0, v16
    s_waitcnt lgkmcnt(0)
    s_barrier
    ds_read_b64_tr_b16 v[176:177], v15 offset:0
    ds_read_b64_tr_b16 v[178:179], v15 offset:512
    ds_read_b128 v[52:55], v17 offset:0
    ds_read_b128 v[56:59], v17 offset:1024
    ds_read_b128 v[60:63], v18 offset:0
    ds_read_b128 v[64:67], v18 offset:1024
    ds_read_b128 v[68:71], v19 offset:0
    ds_read_b128 v[72:75], v19 offset:1024
    s_waitcnt lgkmcnt(6)
    v_lshlrev_b32 v4, 16, v176
    v_and_b32 v5, 0xffff0000, v176
    v_fmac_f32 v44, v16, v4
    v_fmac_f32 v45, v16, v5
    v_lshlrev_b32 v4, 16, v177
    v_and_b32 v5, 0xffff0000, v177
    v_fmac_f32 v46, v16, v4
    v_fmac_f32 v47, v16, v5
    v_lshlrev_b32 v4, 16, v178
    v_and_b32 v5, 0xffff0000, v178
    v_fmac_f32 v48, v16, v4
    v_fmac_f32 v49, v16, v5
    v_lshlrev_b32 v4, 16, v179
    v_and_b32 v5, 0xffff0000, v179
    v_fmac_f32 v50, v16, v4
    v_fmac_f32 v51, v16, v5
    s_waitcnt lgkmcnt(4)
    v_fmac_f32 v44, v3, v52
    v_fmac_f32 v45, v3, v53
    v_fmac_f32 v46, v3, v54
    v_fmac_f32 v47, v3, v55
    v_fmac_f32 v48, v3, v56
    v_fmac_f32 v49, v3, v57
    v_fmac_f32 v50, v3, v58
    v_fmac_f32 v51, v3, v59
    s_waitcnt lgkmcnt(2)
    v_fmac_f32 v44, v3, v60
    v_fmac_f32 v45, v3, v61
    v_fmac_f32 v46, v3, v62
    v_fmac_f32 v47, v3, v63
    v_fmac_f32 v48, v3, v64
    v_fmac_f32 v49, v3, v65
    v_fmac_f32 v50, v3, v66
    v_fmac_f32 v51, v3, v67
    s_waitcnt lgkmcnt(0)
    v_fmac_f32 v44, v3, v68
    v_fmac_f32 v45, v3, v69
    v_fmac_f32 v46, v3, v70
    v_fmac_f32 v47, v3, v71
    v_fmac_f32 v48, v3, v72
    v_fmac_f32 v49, v3, v73
    v_fmac_f32 v50, v3, v74
    v_fmac_f32 v51, v3, v75
    v_cvt_pk_bf16_f32 v188, v44, v45
    v_cvt_pk_bf16_f32 v189, v46, v47
    v_cvt_pk_bf16_f32 v190, v48, v49
    v_cvt_pk_bf16_f32 v191, v50, v51
    buffer_store_dwordx4 v[188:191], v14, s[72:75], s85 offen
    s_endpgm
L_st2:
    s_branch L_stret
L_load:
    s_bfe_u32 s87, s0, 0x30008
    s_mul_i32 s1, s87, 229376
    s_lshl_b32 s87, s87, 7
    s_add_u32 m0, s20, 49152
    s_add_u32 s24, s1, s60
    buffer_load_dwordx4 v6, s[28:31], s24 offen lds
    s_add_u32 m0, s20, 65536
    s_nop 0
    buffer_load_dwordx4 v6, s[56:59], s24 offen lds
    s_add_u32 m0, s86, 24576
    s_nop 0
    buffer_load_dwordx4 v8, s[52:55], s87 offen lds
    s_add_u32 m0, s86, 25600
    s_nop 0
    buffer_load_dwordx4 v9, s[52:55], s87 offen lds
    s_add_u32 m0, s86, 32768
    s_nop 0
    buffer_load_dwordx4 v4, s[52:55], s87 offen lds
    s_add_u32 m0, s86, 33792
    s_nop 0
    buffer_load_dwordx4 v5, s[52:55], s87 offen lds
    s_mov_b32 s14, 0xaaaaaaaa
    s_mov_b32 s15, 0xaaaaaaaa
    v_cndmask_b32 v172, v236, v237, s[14:15]
    v_cndmask_b32 v173, v238, v239, s[14:15]
    v_cvt_pk_bf16_f32 v160, v236, v236
    v_cvt_pk_bf16_f32 v161, v236, v236
    v_cvt_pk_bf16_f32 v162, v172, v237
    v_cvt_pk_bf16_f32 v163, v237, v237
    v_cvt_pk_bf16_f32 v164, v238, v238
    v_cvt_pk_bf16_f32 v165, v238, v238
    v_cvt_pk_bf16_f32 v166, v173, v239
    v_cvt_pk_bf16_f32 v167, v239, v239
    s_mov_b64 exec, 0xffffffff
    v_cvt_pk_bf16_f32 v161, v236, v237
    v_mov_b32 v162, v163
    v_mov_b32 v163, v164
    s_not_b64 exec, exec
    ds_write_b128 v154, v[164:167] offset:1024
    s_mov_b64 exec, -1
    ds_write_b128 v154, v[160:163]
    s_waitcnt vmcnt(6) lgkmcnt(0)
    s_barrier
    s_add_u32 m0, s21, 49152
    s_add_u32 s24, s1, s61
    buffer_load_dwordx4 v6, s[28:31], s24 offen lds
    s_add_u32 m0, s21, 65536
    s_nop 0
    buffer_load_dwordx4 v6, s[56:59], s24 offen lds
    s_add_u32 m0, s22, 49152
    s_add_u32 s24, s1, s62
    buffer_load_dwordx4 v6, s[28:31], s24 offen lds
    s_add_u32 m0, s22, 65536
    s_nop 0
    buffer_load_dwordx4 v6, s[56:59], s24 offen lds
    s_add_u32 m0, s23, 49152
    s_add_u32 s24, s1, s63
    buffer_load_dwordx4 v6, s[28:31], s24 offen lds
    s_add_u32 m0, s23, 65536
    s_nop 0
    buffer_load_dwordx4 v6, s[56:59], s24 offen lds
    s_bfe_u32 s87, s0, 0x3000c
    s_mul_i32 s1, s87, 229376
    s_lshl_b32 s87, s87, 7
    s_add_u32 m0, s20, 81920
    s_add_u32 s24, s1, s60
    buffer_load_dwordx4 v6, s[28:31], s24 offen lds
    s_add_u32 m0, s20, 98304
    s_nop 0
    buffer_load_dwordx4 v6, s[56:59], s24 offen lds
    s_add_u32 m0, s86, 4294959104
    s_nop 0
    buffer_load_dwordx4 v8, s[52:55], s87 offen lds
    s_add_u32 m0, s86, 4294960128
    s_nop 0
    buffer_load_dwordx4 v9, s[52:55], s87 offen lds
    s_add_u32 m0, s86, 0
    s_nop 0
    buffer_load_dwordx4 v4, s[52:55], s87 offen lds
    s_add_u32 m0, s86, 1024
    s_nop 0
    buffer_load_dwordx4 v5, s[52:55], s87 offen lds
    s_cmp_lg_u32 s3, 4
    s_cbranch_scc1 Low_26
    v_mov_b32 v176, 0
    v_bfe_u32 v177, v1, 4, 1
    v_and_b32 v178, 15, v1
    v_mul_u32_u24 v179, 4160, v177
    v_lshl_add_u32 v179, v178, 2, v179
    v_mul_u32_u24 v180, 2064, v177
    v_lshl_add_u32 v180, v178, 2, v180
    v_lshlrev_b32 v181, 2, v1
    s_mov_b64 exec, 0xffffffff
    ds_write_b32 v179, v176 offset:49152
    ds_write_b32 v180, v176 offset:57472
    ds_write_b32 v181, v176 offset:65408
    s_mov_b64 exec, -1
Low_26:
    s_waitcnt vmcnt(6) lgkmcnt(0)
    s_barrier
    s_add_u32 m0, s21, 81920
    s_add_u32 s24, s1, s61
    buffer_load_dwordx4 v6, s[28:31], s24 offen lds
    s_add_u32 m0, s21, 98304
    s_nop 0
    buffer_load_dwordx4 v6, s[56:59], s24 offen lds
    s_add_u32 m0, s22, 81920
    s_add_u32 s24, s1, s62
    buffer_load_dwordx4 v6, s[28:31], s24 offen lds
    s_add_u32 m0, s22, 98304
    s_nop 0
    buffer_load_dwordx4 v6, s[56:59], s24 offen lds
    s_add_u32 m0, s23, 81920
    s_add_u32 s24, s1, s63
    buffer_load_dwordx4 v6, s[28:31], s24 offen lds
    s_add_u32 m0, s23, 98304
    s_nop 0
    buffer_load_dwordx4 v6, s[56:59], s24 offen lds
    s_bfe_u32 s87, s0, 0x30010
    s_mul_i32 s1, s87, 229376
    s_lshl_b32 s87, s87, 7
    s_add_u32 m0, s20, 114688
    s_add_u32 s24, s1, s60
    buffer_load_dwordx4 v6, s[28:31], s24 offen lds
    s_add_u32 m0, s20, 131072
    s_nop 0
    buffer_load_dwordx4 v6, s[56:59], s24 offen lds
    s_add_u32 m0, s86, 8192
    s_nop 0
    buffer_load_dwordx4 v8, s[52:55], s87 offen lds
    s_add_u32 m0, s86, 9216
    s_nop 0
    buffer_load_dwordx4 v9, s[52:55], s87 offen lds
    s_add_u32 m0, s86, 16384
    s_nop 0
    buffer_load_dwordx4 v4, s[52:55], s87 offen lds
    s_add_u32 m0, s86, 17408
    s_nop 0
    buffer_load_dwordx4 v5, s[52:55], s87 offen lds
    s_add_u32 m0, s21, 114688
    s_add_u32 s24, s1, s61
    buffer_load_dwordx4 v6, s[28:31], s24 offen lds
    s_add_u32 m0, s21, 131072
    s_nop 0
    buffer_load_dwordx4 v6, s[56:59], s24 offen lds
    s_mov_b32 s64, s48
    s_and_b32 s65, s49, 0xffff
    s_mov_b32 s68, s40
    s_and_b32 s69, s41, 0xffff
    s_mov_b32 s72, s44
    s_and_b32 s73, s45, 0xffff
    s_and_b32 s80, s4, 6
    s_lshl_b32 s80, s80, 2
    s_and_b32 s10, s5, 7
    s_add_u32 s80, s80, s10
    s_and_b32 s81, s4, 1
    s_lshl_b32 s81, s81, 2
    s_lshr_b32 s10, s5, 3
    s_add_u32 s81, s81, s10
    s_lshr_b32 s82, s3, 2
    s_and_b32 s83, s3, 3
    s_lshl_b32 s10, s80, 1
    s_and_b32 s13, s3, 1
    s_add_u32 s10, s10, s13
    s_mul_i32 s11, s10, 112
    s_lshr_b32 s12, s3, 1
    s_mul_i32 s100, s12, 458752
    s_lshl_b32 s13, s13, 15
    s_add_u32 s100, s100, s13
    s_mul_i32 s13, s12, 28
    s_add_u32 s11, s11, s13
    s_lshl_b32 s84, s11, 10
    s_lshl_b32 s51, s10, 7
    s_waitcnt vmcnt(8) lgkmcnt(0)
    s_barrier
    s_add_u32 m0, s22, 114688
    s_add_u32 s24, s1, s62
    buffer_load_dwordx4 v6, s[28:31], s24 offen lds
    s_add_u32 m0, s22, 131072
    s_nop 0
    buffer_load_dwordx4 v6, s[56:59], s24 offen lds
    s_add_u32 m0, s23, 114688
    s_add_u32 s24, s1, s63
    buffer_load_dwordx4 v6, s[28:31], s24 offen lds
    s_add_u32 m0, s23, 131072
    s_nop 0
    buffer_load_dwordx4 v6, s[56:59], s24 offen lds
    s_bfe_u32 s87, s0, 0x30014
    s_mul_i32 s1, s87, 229376
    s_lshl_b32 s87, s87, 7
    s_add_u32 m0, s20, 49152
    s_add_u32 s24, s1, s60
    buffer_load_dwordx4 v6, s[28:31], s24 offen lds
    s_add_u32 m0, s20, 65536
    s_nop 0
    buffer_load_dwordx4 v6, s[56:59], s24 offen lds
    s_add_u32 m0, s86, 24576
    s_nop 0
    buffer_load_dwordx4 v8, s[52:55], s87 offen lds
    s_add_u32 m0, s86, 25600
    s_nop 0
    buffer_load_dwordx4 v9, s[52:55], s87 offen lds
    s_add_u32 m0, s86, 32768
    s_nop 0
    buffer_load_dwordx4 v4, s[52:55], s87 offen lds
    s_add_u32 m0, s86, 33792
    s_nop 0
    buffer_load_dwordx4 v5, s[52:55], s87 offen lds
    s_add_u32 m0, s21, 49152
    s_add_u32 s24, s1, s61
    buffer_load_dwordx4 v6, s[28:31], s24 offen lds
    s_add_u32 m0, s21, 65536
    s_nop 0
    buffer_load_dwordx4 v6, s[56:59], s24 offen lds
    s_add_u32 m0, s22, 49152
    s_add_u32 s24, s1, s62
    buffer_load_dwordx4 v6, s[28:31], s24 offen lds
    s_add_u32 m0, s22, 65536
    s_nop 0
    buffer_load_dwordx4 v6, s[56:59], s24 offen lds
    s_add_u32 s51, s51, 12582912
    s_lshl_b32 s10, s10, 15
    s_lshl_b32 s11, s81, 7
    s_lshl_b32 s12, s12, 5
    s_add_u32 s50, s11, s12
    s_add_u32 s85, s10, s50
    s_mul_i32 s90, s83, 458752
    s_lshl_b32 s91, s83, 13
    s_mov_b32 s44, 0x6543210
    s_mov_b32 s45, 0x10654321
    s_and_b32 s10, s5, 7
    s_lshl_b32 s10, s10, 2
    s_lshr_b64 s[44:45], s[44:45], s10
    s_bfe_u32 s10, s44, 0x30000
    s_lshl_b32 s36, s10, 12
    s_bfe_u32 s10, s44, 0x30004
    s_lshl_b32 s37, s10, 12
    s_bfe_u32 s10, s44, 0x30008
    s_lshl_b32 s38, s10, 12
    s_bfe_u32 s10, s44, 0x3000c
    s_lshl_b32 s39, s10, 12
    s_bfe_u32 s10, s44, 0x30010
    s_lshl_b32 s40, s10, 12
    s_bfe_u32 s10, s44, 0x30014
    s_lshl_b32 s41, s10, 12
    s_bfe_u32 s10, s44, 0x30018
    s_lshl_b32 s42, s10, 12
    s_waitcnt vmcnt(10) lgkmcnt(0)
    s_barrier
    s_add_u32 m0, s23, 49152
    s_add_u32 s24, s1, s63
    buffer_load_dwordx4 v6, s[28:31], s24 offen lds
    s_add_u32 m0, s23, 65536
    s_nop 0
    buffer_load_dwordx4 v6, s[56:59], s24 offen lds
    s_bfe_u32 s87, s0, 0x30018
    s_mul_i32 s1, s87, 229376
    s_lshl_b32 s87, s87, 7
    s_add_u32 m0, s20, 81920
    s_add_u32 s24, s1, s60
    buffer_load_dwordx4 v6, s[28:31], s24 offen lds
    s_add_u32 m0, s20, 98304
    s_nop 0
    buffer_load_dwordx4 v6, s[56:59], s24 offen lds
    s_add_u32 m0, s86, 4294959104
    s_nop 0
    buffer_load_dwordx4 v8, s[52:55], s87 offen lds
    s_add_u32 m0, s86, 4294960128
    s_nop 0
    buffer_load_dwordx4 v9, s[52:55], s87 offen lds
    s_add_u32 m0, s86, 0
    s_nop 0
    buffer_load_dwordx4 v4, s[52:55], s87 offen lds
    s_add_u32 m0, s86, 1024
    s_nop 0
    buffer_load_dwordx4 v5, s[52:55], s87 offen lds
    s_add_u32 m0, s21, 81920
    s_add_u32 s24, s1, s61
    buffer_load_dwordx4 v6, s[28:31], s24 offen lds
    s_add_u32 m0, s21, 98304
    s_nop 0
    buffer_load_dwordx4 v6, s[56:59], s24 offen lds
    s_add_u32 m0, s22, 81920
    s_add_u32 s24, s1, s62
    buffer_load_dwordx4 v6, s[28:31], s24 offen lds
    s_add_u32 m0, s22, 98304
    s_nop 0
    buffer_load_dwordx4 v6, s[56:59], s24 offen lds
    s_add_u32 m0, s23, 81920
    s_add_u32 s24, s1, s63
    buffer_load_dwordx4 v6, s[28:31], s24 offen lds
    s_add_u32 m0, s23, 98304
    s_nop 0
    buffer_load_dwordx4 v6, s[56:59], s24 offen lds
    v_lshlrev_b32 v240, 4, v1
    v_lshrrev_b32 v14, 3, v1
    v_lshlrev_b32 v14, 10, v14
    v_bfe_u32 v15, v1, 4, 1
    v_lshlrev_b32 v15, 2, v15
    v_and_b32 v16, 7, v1
    v_xor_b32 v16, v16, v15
    v_lshl_add_u32 v14, v16, 4, v14
    v_add_u32 v241, s11, v14
    v_lshrrev_b32 v14, 5, v1
    v_bfe_u32 v15, v1, 2, 2
    v_lshl_add_u32 v14, v14, 2, v15
    v_lshlrev_b32 v14, 7, v14
    v_bfe_u32 v15, v1, 3, 1
    v_lshl_add_u32 v14, v15, 6, v14
    v_bfe_u32 v15, v1, 4, 1
    v_lshl_add_u32 v14, v15, 5, v14
    v_and_b32 v15, 1, v1
    v_lshl_add_u32 v14, v15, 4, v14
    v_bfe_u32 v15, v1, 1, 1
    v_lshl_add_u32 v14, v15, 3, v14
    v_xor_b32 v14, s12, v14
    s_lshl_b32 s12, s12, 8
    v_add_u32 v242, s12, v14
    s_lshl_b32 s10, s3, 2
    s_add_u32 s10, s10, 65408
    v_mov_b32 v243, s10
    s_waitcnt vmcnt(12) lgkmcnt(0)
    s_barrier
    s_bfe_u32 s87, s0, 0x3001c
    s_mul_i32 s1, s87, 229376
    s_lshl_b32 s87, s87, 7
    s_add_u32 m0, s20, 114688
    s_add_u32 s24, s1, s60
    buffer_load_dwordx4 v6, s[28:31], s24 offen lds
    s_add_u32 m0, s20, 131072
    s_nop 0
    buffer_load_dwordx4 v6, s[56:59], s24 offen lds
    s_add_u32 m0, s86, 8192
    s_nop 0
    buffer_load_dwordx4 v8, s[52:55], s87 offen lds
    s_add_u32 m0, s86, 9216
    s_nop 0
    buffer_load_dwordx4 v9, s[52:55], s87 offen lds
    s_add_u32 m0, s86, 16384
    s_nop 0
    buffer_load_dwordx4 v4, s[52:55], s87 offen lds
    s_add_u32 m0, s86, 17408
    s_nop 0
    buffer_load_dwordx4 v5, s[52:55], s87 offen lds
    s_add_u32 m0, s21, 114688
    s_add_u32 s24, s1, s61
    buffer_load_dwordx4 v6, s[28:31], s24 offen lds
    s_add_u32 m0, s21, 131072
    s_nop 0
    buffer_load_dwordx4 v6, s[56:59], s24 offen lds
    s_add_u32 m0, s22, 114688
    s_add_u32 s24, s1, s62
    buffer_load_dwordx4 v6, s[28:31], s24 offen lds
    s_add_u32 m0, s22, 131072
    s_nop 0
    buffer_load_dwordx4 v6, s[56:59], s24 offen lds
    s_add_u32 m0, s23, 114688
    s_add_u32 s24, s1, s63
    buffer_load_dwordx4 v6, s[28:31], s24 offen lds
    s_add_u32 m0, s23, 131072
    s_nop 0
    buffer_load_dwordx4 v6, s[56:59], s24 offen lds
    s_bfe_u32 s10, s3, 0x10001
    v_lshrrev_b32 v14, 5, v1
    v_lshlrev_b32 v2, 6, v14
    v_and_b32 v15, 31, v1
    v_lshlrev_b32 v3, 4, v15
    v_sub_u32 v3, v3, v2
    v_and_b32 v16, 1, v1
    v_lshl_add_u32 v2, v16, 5, v2
    v_lshrrev_b32 v15, 2, v15
    v_lshl_add_u32 v15, v15, 1, v14
    v_lshlrev_b32 v5, 5, v15
    v_lshl_add_u32 v5, v16, 4, v5
    s_mul_i32 s11, s10, 2064
    s_add_u32 s11, s11, 57472
    v_lshl_add_u32 v4, v15, 4, s11
    v_bfe_u32 v16, v1, 4, 1
    v_lshl_add_u32 v2, v16, 4, v2
    v_bfe_u32 v16, v1, 1, 1
    v_lshl_add_u32 v2, v16, 3, v2
    v_bfe_u32 v16, v1, 2, 2
    v_lshlrev_b32 v16, 3, v16
    v_sub_u32 v2, v2, v16
    s_mul_i32 s11, s10, 4160
    s_add_u32 s11, s11, 49184
    v_add_u32 v2, s11, v2
    s_mul_i32 s11, s10, 4608
    s_add_u32 s11, s11, 32896
    v_add_u32 v3, s11, v3
    s_lshl_b32 s11, s2, 1
    s_add_u32 s11, s11, s10
    s_lshl_b32 s11, s11, 12
    s_add_u32 s89, s11, 10485760
    v_mov_b32 v6, 1
    v_mov_b32 v7, 65408
    s_lshl_b32 s10, s83, 4
    s_add_u32 s10, s10, 65440
    v_mov_b32 v108, s10
    v_xor_b32 v109, 16, v108
    s_waitcnt vmcnt(12) lgkmcnt(0)
    s_barrier
    v_and_b32 v64, 31, v1
    v_lshrrev_b32 v65, 5, v1
    v_lshlrev_b32 v66, 4, v65
    v_lshl_add_u32 v64, v64, 10, v66
    buffer_load_dwordx4 v[56:59], v64, s[52:55], s85 offen
    v_add_u32 v66, s50, v66
    global_load_dwordx4 v[60:63], v66, s[32:33]
    s_cmp_lg_u32 s3, 5
    s_cbranch_scc1 Low_27
    v_mov_b32 v236, 0
    v_mov_b32 v237, 0
    v_mov_b32 v238, 0
    v_mov_b32 v239, 0
    v_and_b32 v233, 31, v1
    v_lshlrev_b32 v233, 4, v233
    v_lshrrev_b32 v234, 5, v1
    v_mul_u32_u24 v234, 4608, v234
    v_add_u32 v233, v233, v234
    ds_write_b128 v233, v[236:239] offset:32768
Low_27:
    s_mov_b32 s79, 12648448
    v_min_u32 v252, 31, v1
    v_lshlrev_b32 v252, 2, v252
    buffer_load_dword v249, v252, s[64:67], s79 offen sc1
    global_load_dwordx2 v[250:251], v235, s[46:47] sc1
    s_add_u32 m0, s91, 65536
    s_lshl_b32 s13, s36, 4
    s_add_u32 s13, s13, s90
    buffer_load_dwordx4 v241, s[68:71], s13 offen lds
    s_add_u32 m0, s91, 66560
    s_add_u32 s13, s13, 8192
    buffer_load_dwordx4 v241, s[68:71], s13 offen lds
    s_add_u32 m0, s91, 67584
    s_add_u32 s13, s13, 8192
    buffer_load_dwordx4 v241, s[68:71], s13 offen lds
    s_add_u32 m0, s91, 68608
    s_add_u32 s13, s13, 8192
    buffer_load_dwordx4 v241, s[68:71], s13 offen lds
    s_add_u32 m0, s91, 69632
    s_add_u32 s13, s13, 8192
    buffer_load_dwordx4 v241, s[68:71], s13 offen lds
    s_add_u32 m0, s91, 70656
    s_add_u32 s13, s13, 8192
    buffer_load_dwordx4 v241, s[68:71], s13 offen lds
    s_add_u32 m0, s91, 71680
    s_add_u32 s13, s13, 8192
    buffer_load_dwordx4 v241, s[68:71], s13 offen lds
    s_add_u32 m0, s91, 72704
    s_add_u32 s13, s13, 8192
    buffer_load_dwordx4 v241, s[68:71], s13 offen lds
    s_waitcnt vmcnt(12) lgkmcnt(0)
    s_barrier
    s_waitcnt vmcnt(8)
Lnok_28r:
    v_readfirstlane_b32 s10, v251
    v_readfirstlane_b32 s76, v250
    s_cmp_lg_u32 s10, 1
    s_cbranch_scc1 Lnlp_29
Lnok_28:
    s_cmp_lg_u32 s3, 4
    s_cbranch_scc1 Low_30
    s_mov_b64 exec, 1
    ds_write_b32 v235, v250 offset:65508
    s_mov_b64 exec, -1
Low_30:
    v_cmp_ne_u32 vcc, s76, v249
    s_nop 0
    s_cmp_lg_u64 vcc, 0
    s_cselect_b32 s101, 1, 0
    s_cbranch_scc1 L_udef
    v_lshlrev_b32 v248, 5, v1
    s_lshl_b32 s10, s2, 13
    s_lshl_b32 s11, s83, 11
    s_add_u32 s10, s10, s11
    s_add_u32 s10, s10, 8388608
    buffer_load_dwordx4 v[244:247], v248, s[64:67], s10 offen sc1
    buffer_load_dwordx4 v[156:159], v248, s[64:67], s10 offen offset:16 sc1
L_udef:
    s_add_u32 m0, s91, 98304
    s_lshl_b32 s13, s37, 4
    s_add_u32 s13, s13, s90
    buffer_load_dwordx4 v241, s[68:71], s13 offen lds
    s_add_u32 m0, s91, 99328
    s_add_u32 s13, s13, 8192
    buffer_load_dwordx4 v241, s[68:71], s13 offen lds
    s_add_u32 m0, s91, 100352
    s_add_u32 s13, s13, 8192
    buffer_load_dwordx4 v241, s[68:71], s13 offen lds
    s_add_u32 m0, s91, 101376
    s_add_u32 s13, s13, 8192
    buffer_load_dwordx4 v241, s[68:71], s13 offen lds
    s_add_u32 m0, s91, 102400
    s_add_u32 s13, s13, 8192
    buffer_load_dwordx4 v241, s[68:71], s13 offen lds
    s_add_u32 m0, s91, 103424
    s_add_u32 s13, s13, 8192
    buffer_load_dwordx4 v241, s[68:71], s13 offen lds
    s_add_u32 m0, s91, 104448
    s_add_u32 s13, s13, 8192
    buffer_load_dwordx4 v241, s[68:71], s13 offen lds
    s_add_u32 m0, s91, 105472
    s_add_u32 s13, s13, 8192
    buffer_load_dwordx4 v241, s[68:71], s13 offen lds
    s_waitcnt lgkmcnt(0)
    s_barrier
    s_cmp_eq_u32 s101, 0
    s_cbranch_scc1 L_uok
Lpok_31r:
    v_cmp_ne_u32 vcc, s76, v249
    s_nop 0
    s_cmp_lg_u64 vcc, 0
    s_cbranch_scc1 Lplp_32
Lpok_31:
    v_lshlrev_b32 v248, 5, v1
    s_lshl_b32 s10, s2, 13
    s_lshl_b32 s11, s83, 11
    s_add_u32 s10, s10, s11
    s_add_u32 s10, s10, 8388608
    buffer_load_dwordx4 v[244:247], v248, s[64:67], s10 offen sc1
    buffer_load_dwordx4 v[156:159], v248, s[64:67], s10 offen offset:16 sc1
    s_waitcnt vmcnt(0)
L_uok:
    s_waitcnt vmcnt(8)
    s_lshl_b32 s11, s83, 10
    v_add_u32 v248, s11, v240
    ds_write_b128 v248, v[244:247] offset:33280
    ds_write_b128 v248, v[156:159] offset:37888
    s_mov_b64 exec, 1
    ds_write_b32 v243, v6 offset:0
    s_mov_b64 exec, -1
    v_lshlrev_b32 v64, 16, v56
    v_lshlrev_b32 v65, 16, v60
    v_and_b32 v56, 0xffff0000, v56
    v_and_b32 v60, 0xffff0000, v60
    v_mul_f32 v64, v64, v65
    v_mul_f32 v65, v56, v60
    v_cvt_pk_bf16_f32 v244, v64, v65
    v_lshlrev_b32 v64, 16, v57
    v_lshlrev_b32 v65, 16, v61
    v_and_b32 v57, 0xffff0000, v57
    v_and_b32 v61, 0xffff0000, v61
    v_mul_f32 v64, v64, v65
    v_mul_f32 v65, v57, v61
    v_cvt_pk_bf16_f32 v245, v64, v65
    v_lshlrev_b32 v64, 16, v58
    v_lshlrev_b32 v65, 16, v62
    v_and_b32 v58, 0xffff0000, v58
    v_and_b32 v62, 0xffff0000, v62
    v_mul_f32 v64, v64, v65
    v_mul_f32 v65, v58, v62
    v_cvt_pk_bf16_f32 v246, v64, v65
    v_lshlrev_b32 v64, 16, v59
    v_lshlrev_b32 v65, 16, v63
    v_and_b32 v59, 0xffff0000, v59
    v_and_b32 v63, 0xffff0000, v63
    v_mul_f32 v64, v64, v65
    v_mul_f32 v65, v59, v63
    v_cvt_pk_bf16_f32 v247, v64, v65
    v_and_b32 v19, 3, v1
    v_lshlrev_b32 v19, 2, v19
Llw_33:
    ds_read_b32 v18, v19 offset:65424
    s_add_u32 s78, s78, 1
    s_waitcnt lgkmcnt(0)
    v_cmp_eq_u32 vcc, 0, v18
    s_nop 0
    s_cmp_eq_u64 vcc, 0
    s_cbranch_scc1 Llok_34
    s_cmp_lt_u32 s78, 32000000
    s_cbranch_scc1 Llw_33
Llok_34:
L_conv:
    s_mov_b32 s14, 0x11111111
    s_mov_b32 s15, 0x11111111
    s_mov_b64 vcc, s[14:15]
    s_mov_b32 s12, 0x33333333
    s_mov_b32 s13, 0x33333333
    s_bitcmp1_b32 s3, 0
    s_cbranch_scc1 L_set1
    ds_read_b64_tr_b16 v[8:9], v2 offset:32
    ds_read_b64_tr_b16 v[10:11], v2 offset:0
    ds_read_b128 v[124:127], v3 offset:384
    ds_read_b128 v[172:175], v3 offset:1920
    ds_read_b128 v[188:191], v3 offset:2432
    ds_read_b128 v[236:239], v3 offset:3968
    ds_read_b64_tr_b16 v[12:13], v2 offset:160
    ds_read_b64_tr_b16 v[14:15], v2 offset:128
    ds_read_b128 v[120:123], v3 offset:256
    ds_read_b128 v[168:171], v3 offset:1792
    ds_read_b128 v[184:187], v3 offset:2304
    s_waitcnt lgkmcnt(8)
    v_mfma_f32_32x32x16_bf16 v[28:43], v[8:11], v[124:127], 0
    ds_read_b128 v[232:235], v3 offset:3840
    s_waitcnt lgkmcnt(8)
    v_mfma_f32_32x32x16_bf16 v[48:63], v[8:11], v[172:175], 0
    ds_read_b64_tr_b16 v[16:17], v2 offset:288
    ds_read_b64_tr_b16 v[18:19], v2 offset:256
    ds_read_b128 v[116:119], v3 offset:128
    s_waitcnt lgkmcnt(10)
    v_mfma_f32_32x32x16_bf16 v[68:83], v[8:11], v[188:191], 0
    ds_read_b128 v[164:167], v3 offset:1664
    s_waitcnt lgkmcnt(10)
    v_mfma_f32_32x32x16_bf16 v[88:103], v[8:11], v[236:239], 0
    ds_read_b128 v[180:183], v3 offset:2176
    s_waitcnt lgkmcnt(8)
    v_mfma_f32_32x32x16_bf16 v[28:43], v[12:15], v[120:123], v[28:43]
    ds_read_b128 v[228:231], v3 offset:3712
    s_waitcnt lgkmcnt(8)
    v_mfma_f32_32x32x16_bf16 v[48:63], v[12:15], v[168:171], v[48:63]
    ds_read_b64_tr_b16 v[20:21], v2 offset:416
    ds_read_b64_tr_b16 v[22:23], v2 offset:384
    ds_read_b128 v[112:115], v3 offset:0
    s_waitcnt lgkmcnt(10)
    v_mfma_f32_32x32x16_bf16 v[68:83], v[12:15], v[184:187], v[68:83]
    ds_read_b128 v[160:163], v3 offset:1536
    s_waitcnt lgkmcnt(10)
    v_mfma_f32_32x32x16_bf16 v[88:103], v[12:15], v[232:235], v[88:103]
    ds_read_b128 v[176:179], v3 offset:2048
    s_waitcnt lgkmcnt(8)
    v_mfma_f32_32x32x16_bf16 v[28:43], v[16:19], v[116:119], v[28:43]
    ds_read_b128 v[224:227], v3 offset:3584
    s_waitcnt lgkmcnt(8)
    v_mfma_f32_32x32x16_bf16 v[48:63], v[16:19], v[164:167], v[48:63]
    ds_read_b64_tr_b16 v[24:25], v2 offset:544
    ds_read_b64_tr_b16 v[26:27], v2 offset:512
    ds_read_b128 v[156:159], v3 offset:1408
    s_waitcnt lgkmcnt(10)
    v_mfma_f32_32x32x16_bf16 v[68:83], v[16:19], v[180:183], v[68:83]
    s_waitcnt lgkmcnt(9)
    v_mfma_f32_32x32x16_bf16 v[88:103], v[16:19], v[228:231], v[88:103]
    ds_read_b128 v[220:223], v3 offset:3456
    s_waitcnt lgkmcnt(7)
    v_mfma_f32_32x32x16_bf16 v[28:43], v[20:23], v[112:115], v[28:43]
    ds_read_b64_tr_b16 v[8:9], v2 offset:672
    ds_read_b64_tr_b16 v[10:11], v2 offset:640
    ds_read_b128 v[152:155], v3 offset:1280
    s_waitcnt lgkmcnt(9)
    v_mfma_f32_32x32x16_bf16 v[48:63], v[20:23], v[160:163], v[48:63]
    s_waitcnt lgkmcnt(8)
    v_mfma_f32_32x32x16_bf16 v[68:83], v[20:23], v[176:179], v[68:83]
    ds_read_b128 v[216:219], v3 offset:3328
    s_waitcnt lgkmcnt(8)
    v_mfma_f32_32x32x16_bf16 v[88:103], v[20:23], v[224:227], v[88:103]
    s_nop 1
    v_mov_b32_dpp v44, v43 quad_perm:[1,1,3,3] row_mask:0xf bank_mask:0xf
    v_add_f32_dpp v43, v42, v43 quad_perm:[1,1,3,3] row_mask:0xf bank_mask:0xf
    v_add_f32_dpp v42, v41, v42 quad_perm:[1,1,3,3] row_mask:0xf bank_mask:0xf
    v_add_f32_dpp v41, v40, v41 quad_perm:[1,1,3,3] row_mask:0xf bank_mask:0xf
    ds_read_b64_tr_b16 v[12:13], v2 offset:800
    ds_read_b64_tr_b16 v[14:15], v2 offset:768
    ds_read_b128 v[148:151], v3 offset:1152
    s_waitcnt lgkmcnt(8)
    v_mfma_f32_32x32x16_bf16 v[48:63], v[24:27], v[156:159], v[48:63]
    v_add_f32_dpp v40, v39, v40 quad_perm:[1,1,3,3] row_mask:0xf bank_mask:0xf
    v_add_f32_dpp v39, v38, v39 quad_perm:[1,1,3,3] row_mask:0xf bank_mask:0xf
    v_add_f32_dpp v38, v37, v38 quad_perm:[1,1,3,3] row_mask:0xf bank_mask:0xf
    v_add_f32_dpp v37, v36, v37 quad_perm:[1,1,3,3] row_mask:0xf bank_mask:0xf
    v_mfma_f32_32x32x16_bf16 v[68:83], v[24:27], v[172:175], v[68:83]
    v_add_f32_dpp v36, v35, v36 quad_perm:[1,1,3,3] row_mask:0xf bank_mask:0xf
    v_add_f32_dpp v35, v34, v35 quad_perm:[1,1,3,3] row_mask:0xf bank_mask:0xf
    v_add_f32_dpp v34, v33, v34 quad_perm:[1,1,3,3] row_mask:0xf bank_mask:0xf
    v_add_f32_dpp v33, v32, v33 quad_perm:[1,1,3,3] row_mask:0xf bank_mask:0xf
    ds_read_b128 v[212:215], v3 offset:3200
    s_waitcnt lgkmcnt(8)
    v_mfma_f32_32x32x16_bf16 v[88:103], v[24:27], v[220:223], v[88:103]
    v_add_f32_dpp v32, v31, v32 quad_perm:[1,1,3,3] row_mask:0xf bank_mask:0xf
    v_add_f32_dpp v31, v30, v31 quad_perm:[1,1,3,3] row_mask:0xf bank_mask:0xf
    v_add_f32_dpp v30, v29, v30 quad_perm:[1,1,3,3] row_mask:0xf bank_mask:0xf
    v_add_f32_dpp v29, v28, v29 quad_perm:[1,1,3,3] row_mask:0xf bank_mask:0xf
    ds_read_b64_tr_b16 v[16:17], v2 offset:928
    ds_read_b64_tr_b16 v[18:19], v2 offset:896
    ds_read_b128 v[144:147], v3 offset:1024
    s_waitcnt lgkmcnt(8)
    v_mfma_f32_32x32x16_bf16 v[48:63], v[8:11], v[152:155], v[48:63]
    v_mov_b32_dpp v46, v44 quad_perm:[2,2,2,2] row_mask:0xf bank_mask:0xf
    v_mov_b32_dpp v45, v43 quad_perm:[2,2,2,2] row_mask:0xf bank_mask:0xf
    v_add_f32_dpp v44, v42, v44 quad_perm:[2,2,2,2] row_mask:0xf bank_mask:0xf
    s_mov_b64 exec, vcc
    ds_write_b128 v4, v[44:47] offset:16
    s_mov_b64 exec, 1
    ds_write_b32 v108, v6 offset:0
    s_mov_b64 exec, -1
    v_mfma_f32_32x32x16_bf16 v[68:83], v[8:11], v[168:171], v[68:83]
    v_add_f32_dpp v43, v41, v43 quad_perm:[2,2,2,2] row_mask:0xf bank_mask:0xf
    v_add_f32_dpp v42, v40, v42 quad_perm:[2,2,2,2] row_mask:0xf bank_mask:0xf
    v_add_f32_dpp v41, v39, v41 quad_perm:[2,2,2,2] row_mask:0xf bank_mask:0xf
    v_add_f32_dpp v40, v38, v40 quad_perm:[2,2,2,2] row_mask:0xf bank_mask:0xf
    ds_read_b128 v[208:211], v3 offset:3072
    s_waitcnt lgkmcnt(10)
    v_mfma_f32_32x32x16_bf16 v[88:103], v[8:11], v[216:219], v[88:103]
    v_add_f32_dpp v39, v37, v39 quad_perm:[2,2,2,2] row_mask:0xf bank_mask:0xf
    v_add_f32_dpp v38, v36, v38 quad_perm:[2,2,2,2] row_mask:0xf bank_mask:0xf
    v_add_f32_dpp v37, v35, v37 quad_perm:[2,2,2,2] row_mask:0xf bank_mask:0xf
    v_add_f32_dpp v36, v34, v36 quad_perm:[2,2,2,2] row_mask:0xf bank_mask:0xf
    ds_read_b64_tr_b16 v[20:21], v2 offset:1056
    ds_read_b64_tr_b16 v[22:23], v2 offset:1024
    ds_read_b128 v[140:143], v3 offset:896
    s_waitcnt lgkmcnt(10)
    v_mfma_f32_32x32x16_bf16 v[48:63], v[12:15], v[148:151], v[48:63]
    v_add_f32_dpp v35, v33, v35 quad_perm:[2,2,2,2] row_mask:0xf bank_mask:0xf
    v_add_f32_dpp v34, v32, v34 quad_perm:[2,2,2,2] row_mask:0xf bank_mask:0xf
    v_add_f32_dpp v33, v31, v33 quad_perm:[2,2,2,2] row_mask:0xf bank_mask:0xf
    v_add_f32_dpp v32, v30, v32 quad_perm:[2,2,2,2] row_mask:0xf bank_mask:0xf
    v_mfma_f32_32x32x16_bf16 v[68:83], v[12:15], v[164:167], v[68:83]
    v_add_f32_dpp v31, v29, v31 quad_perm:[2,2,2,2] row_mask:0xf bank_mask:0xf
    v_add_f32_dpp v30, v28, v30 quad_perm:[2,2,2,2] row_mask:0xf bank_mask:0xf
    v_cvt_pk_bf16_f32 v44, v32, v33
    v_cvt_pk_bf16_f32 v45, v34, v35
    ds_read_b128 v[204:207], v3 offset:2944
    s_waitcnt lgkmcnt(10)
    v_mfma_f32_32x32x16_bf16 v[88:103], v[12:15], v[212:215], v[88:103]
    v_cvt_pk_bf16_f32 v32, v36, v37
    v_cvt_pk_bf16_f32 v33, v38, v39
    v_cvt_pk_bf16_f32 v34, v40, v41
    v_cvt_pk_bf16_f32 v35, v42, v43
    ds_read_b64_tr_b16 v[24:25], v2 offset:1184
    ds_read_b64_tr_b16 v[26:27], v2 offset:1152
    ds_read_b128 v[136:139], v3 offset:768
    s_waitcnt lgkmcnt(10)
    v_mfma_f32_32x32x16_bf16 v[48:63], v[16:19], v[144:147], v[48:63]
    ds_read_b128 v[36:39], v4 offset:0
    v_mfma_f32_32x32x16_bf16 v[68:83], v[16:19], v[160:163], v[68:83]
    ds_read_b128 v[200:203], v3 offset:2816
    s_waitcnt lgkmcnt(9)
    v_mfma_f32_32x32x16_bf16 v[88:103], v[16:19], v[208:211], v[88:103]
    ds_read_b64_tr_b16 v[8:9], v2 offset:1312
    ds_read_b64_tr_b16 v[10:11], v2 offset:1280
    ds_read_b128 v[132:135], v3 offset:640
    s_waitcnt lgkmcnt(9)
    v_mfma_f32_32x32x16_bf16 v[48:63], v[20:23], v[140:143], v[48:63]
    s_waitcnt lgkmcnt(4)
    v_add_f32 v28, v28, v36
    v_add_f32 v29, v29, v37
    v_add_f32 v30, v30, v38
    v_mfma_f32_32x32x16_bf16 v[68:83], v[20:23], v[156:159], v[68:83]
    v_cvt_pk_bf16_f32 v28, v28, v29
    v_cvt_pk_bf16_f32 v29, v30, v31
    v_cndmask_b32_dpp v30, v34, v44, vcc quad_perm:[0,0,0,0] row_mask:0xf bank_mask:0xf
    v_cndmask_b32_dpp v31, v35, v45, vcc quad_perm:[0,0,0,0] row_mask:0xf bank_mask:0xf
    ds_read_b128 v[196:199], v3 offset:2688
    v_mfma_f32_32x32x16_bf16 v[88:103], v[20:23], v[204:207], v[88:103]
    v_cndmask_b32_dpp v28, v32, v28, vcc quad_perm:[0,0,0,0] row_mask:0xf bank_mask:0xf
    v_cndmask_b32_dpp v29, v33, v29, vcc quad_perm:[0,0,0,0] row_mask:0xf bank_mask:0xf
    ds_read_b64_tr_b16 v[12:13], v2 offset:1440
    ds_read_b64_tr_b16 v[14:15], v2 offset:1408
    ds_read_b128 v[128:131], v3 offset:512
    v_mfma_f32_32x32x16_bf16 v[48:63], v[24:27], v[136:139], v[48:63]
    v_mfma_f32_32x32x16_bf16 v[68:83], v[24:27], v[152:155], v[68:83]
    ds_read_b128 v[192:195], v3 offset:2560
    s_waitcnt lgkmcnt(8)
    v_mfma_f32_32x32x16_bf16 v[88:103], v[24:27], v[200:203], v[88:103]
    ds_read_b64_tr_b16 v[16:17], v2 offset:1568
    ds_read_b64_tr_b16 v[18:19], v2 offset:1536
    s_waitcnt lgkmcnt(7)
    v_mfma_f32_32x32x16_bf16 v[48:63], v[8:11], v[132:135], v[48:63]
    v_mfma_f32_32x32x16_bf16 v[68:83], v[8:11], v[148:151], v[68:83]
    s_waitcnt lgkmcnt(6)
    v_mfma_f32_32x32x16_bf16 v[88:103], v[8:11], v[196:199], v[88:103]
    ds_read_b64_tr_b16 v[20:21], v2 offset:1696
    ds_read_b64_tr_b16 v[22:23], v2 offset:1664
    s_waitcnt lgkmcnt(5)
    v_mfma_f32_32x32x16_bf16 v[48:63], v[12:15], v[128:131], v[48:63]
    v_mfma_f32_32x32x16_bf16 v[68:83], v[12:15], v[144:147], v[68:83]
    s_waitcnt lgkmcnt(4)
    v_mfma_f32_32x32x16_bf16 v[88:103], v[12:15], v[192:195], v[88:103]
    ds_read_b64_tr_b16 v[24:25], v2 offset:1824
    ds_read_b64_tr_b16 v[26:27], v2 offset:1792
    s_waitcnt lgkmcnt(4)
    v_mfma_f32_32x32x16_bf16 v[48:63], v[16:19], v[124:127], v[48:63]
    v_mfma_f32_32x32x16_bf16 v[68:83], v[16:19], v[140:143], v[68:83]
    v_mfma_f32_32x32x16_bf16 v[88:103], v[16:19], v[188:191], v[88:103]
    ds_read_b64_tr_b16 v[8:9], v2 offset:1952
    ds_read_b64_tr_b16 v[10:11], v2 offset:1920
    s_waitcnt lgkmcnt(4)
    v_mfma_f32_32x32x16_bf16 v[48:63], v[20:23], v[120:123], v[48:63]
    v_mfma_f32_32x32x16_bf16 v[68:83], v[20:23], v[136:139], v[68:83]
    v_mfma_f32_32x32x16_bf16 v[88:103], v[20:23], v[184:187], v[88:103]
    ds_read_b64_tr_b16 v[12:13], v2 offset:2080
    ds_read_b64_tr_b16 v[14:15], v2 offset:2048
    s_waitcnt lgkmcnt(4)
    v_mfma_f32_32x32x16_bf16 v[48:63], v[24:27], v[116:119], v[48:63]
    v_mfma_f32_32x32x16_bf16 v[68:83], v[24:27], v[132:135], v[68:83]
    ds_read_b64_tr_b16 v[16:17], v2 offset:2208
    ds_read_b64_tr_b16 v[18:19], v2 offset:2176
    v_mfma_f32_32x32x16_bf16 v[88:103], v[24:27], v[180:183], v[88:103]
    s_waitcnt lgkmcnt(4)
    v_mfma_f32_32x32x16_bf16 v[48:63], v[8:11], v[112:115], v[48:63]
    ds_read_b64_tr_b16 v[20:21], v2 offset:2336
    ds_read_b64_tr_b16 v[22:23], v2 offset:2304
    v_mfma_f32_32x32x16_bf16 v[68:83], v[8:11], v[128:131], v[68:83]
    v_mfma_f32_32x32x16_bf16 v[88:103], v[8:11], v[176:179], v[88:103]
    ds_read_b64_tr_b16 v[24:25], v2 offset:2464
    ds_read_b64_tr_b16 v[26:27], v2 offset:2432
    s_waitcnt lgkmcnt(6)
    v_mfma_f32_32x32x16_bf16 v[68:83], v[12:15], v[124:127], v[68:83]
    s_nop 3
    v_mov_b32_dpp v64, v63 quad_perm:[1,1,3,3] row_mask:0xf bank_mask:0xf
    v_add_f32_dpp v63, v62, v63 quad_perm:[1,1,3,3] row_mask:0xf bank_mask:0xf
    v_add_f32_dpp v62, v61, v62 quad_perm:[1,1,3,3] row_mask:0xf bank_mask:0xf
    v_add_f32_dpp v61, v60, v61 quad_perm:[1,1,3,3] row_mask:0xf bank_mask:0xf
    v_mfma_f32_32x32x16_bf16 v[88:103], v[12:15], v[172:175], v[88:103]
    v_add_f32_dpp v60, v59, v60 quad_perm:[1,1,3,3] row_mask:0xf bank_mask:0xf
    v_add_f32_dpp v59, v58, v59 quad_perm:[1,1,3,3] row_mask:0xf bank_mask:0xf
    v_add_f32_dpp v58, v57, v58 quad_perm:[1,1,3,3] row_mask:0xf bank_mask:0xf
    v_add_f32_dpp v57, v56, v57 quad_perm:[1,1,3,3] row_mask:0xf bank_mask:0xf
    ds_read_b64_tr_b16 v[8:9], v2 offset:2592
    ds_read_b64_tr_b16 v[10:11], v2 offset:2560
    s_waitcnt lgkmcnt(6)
    v_mfma_f32_32x32x16_bf16 v[68:83], v[16:19], v[120:123], v[68:83]
    v_add_f32_dpp v56, v55, v56 quad_perm:[1,1,3,3] row_mask:0xf bank_mask:0xf
    v_add_f32_dpp v55, v54, v55 quad_perm:[1,1,3,3] row_mask:0xf bank_mask:0xf
    v_add_f32_dpp v54, v53, v54 quad_perm:[1,1,3,3] row_mask:0xf bank_mask:0xf
    v_add_f32_dpp v53, v52, v53 quad_perm:[1,1,3,3] row_mask:0xf bank_mask:0xf
    ds_read_b64_tr_b16 v[12:13], v2 offset:2720
    ds_read_b64_tr_b16 v[14:15], v2 offset:2688
    v_mfma_f32_32x32x16_bf16 v[88:103], v[16:19], v[168:171], v[88:103]
    v_add_f32_dpp v52, v51, v52 quad_perm:[1,1,3,3] row_mask:0xf bank_mask:0xf
    v_add_f32_dpp v51, v50, v51 quad_perm:[1,1,3,3] row_mask:0xf bank_mask:0xf
    v_add_f32_dpp v50, v49, v50 quad_perm:[1,1,3,3] row_mask:0xf bank_mask:0xf
    v_add_f32_dpp v49, v48, v49 quad_perm:[1,1,3,3] row_mask:0xf bank_mask:0xf
    ds_read_b64_tr_b16 v[16:17], v2 offset:2848
    ds_read_b64_tr_b16 v[18:19], v2 offset:2816
    s_waitcnt lgkmcnt(8)
    v_mfma_f32_32x32x16_bf16 v[68:83], v[20:23], v[116:119], v[68:83]
    v_mov_b32_dpp v66, v64 quad_perm:[2,2,2,2] row_mask:0xf bank_mask:0xf
    v_mov_b32_dpp v65, v63 quad_perm:[2,2,2,2] row_mask:0xf bank_mask:0xf
    v_add_f32_dpp v64, v62, v64 quad_perm:[2,2,2,2] row_mask:0xf bank_mask:0xf
    s_mov_b64 exec, vcc
    ds_write_b128 v4, v[64:67] offset:784
    s_mov_b64 exec, -1
    v_mfma_f32_32x32x16_bf16 v[88:103], v[20:23], v[164:167], v[88:103]
    v_add_f32_dpp v63, v61, v63 quad_perm:[2,2,2,2] row_mask:0xf bank_mask:0xf
    v_add_f32_dpp v62, v60, v62 quad_perm:[2,2,2,2] row_mask:0xf bank_mask:0xf
    v_add_f32_dpp v61, v59, v61 quad_perm:[2,2,2,2] row_mask:0xf bank_mask:0xf
    v_add_f32_dpp v60, v58, v60 quad_perm:[2,2,2,2] row_mask:0xf bank_mask:0xf
    ds_read_b64_tr_b16 v[20:21], v2 offset:2976
    ds_read_b64_tr_b16 v[22:23], v2 offset:2944
    s_waitcnt lgkmcnt(9)
    v_mfma_f32_32x32x16_bf16 v[68:83], v[24:27], v[112:115], v[68:83]
    v_add_f32_dpp v59, v57, v59 quad_perm:[2,2,2,2] row_mask:0xf bank_mask:0xf
    v_add_f32_dpp v58, v56, v58 quad_perm:[2,2,2,2] row_mask:0xf bank_mask:0xf
    v_add_f32_dpp v57, v55, v57 quad_perm:[2,2,2,2] row_mask:0xf bank_mask:0xf
    v_add_f32_dpp v56, v54, v56 quad_perm:[2,2,2,2] row_mask:0xf bank_mask:0xf
    v_mfma_f32_32x32x16_bf16 v[88:103], v[24:27], v[160:163], v[88:103]
    v_add_f32_dpp v55, v53, v55 quad_perm:[2,2,2,2] row_mask:0xf bank_mask:0xf
    v_add_f32_dpp v54, v52, v54 quad_perm:[2,2,2,2] row_mask:0xf bank_mask:0xf
    v_add_f32_dpp v53, v51, v53 quad_perm:[2,2,2,2] row_mask:0xf bank_mask:0xf
    v_add_f32_dpp v52, v50, v52 quad_perm:[2,2,2,2] row_mask:0xf bank_mask:0xf
    ds_read_b64_tr_b16 v[24:25], v2 offset:3104
    ds_read_b64_tr_b16 v[26:27], v2 offset:3072
    s_waitcnt lgkmcnt(9)
    v_mfma_f32_32x32x16_bf16 v[88:103], v[8:11], v[156:159], v[88:103]
    v_add_f32_dpp v51, v49, v51 quad_perm:[2,2,2,2] row_mask:0xf bank_mask:0xf
    v_add_f32_dpp v50, v48, v50 quad_perm:[2,2,2,2] row_mask:0xf bank_mask:0xf
    v_cvt_pk_bf16_f32 v64, v52, v53
    v_cvt_pk_bf16_f32 v65, v54, v55
    ds_read_b64_tr_b16 v[8:9], v2 offset:3232
    ds_read_b64_tr_b16 v[10:11], v2 offset:3200
    s_waitcnt lgkmcnt(9)
    v_mfma_f32_32x32x16_bf16 v[88:103], v[12:15], v[152:155], v[88:103]
    v_cvt_pk_bf16_f32 v52, v56, v57
    v_cvt_pk_bf16_f32 v53, v58, v59
    v_cvt_pk_bf16_f32 v54, v60, v61
    v_cvt_pk_bf16_f32 v55, v62, v63
    ds_read_b64_tr_b16 v[12:13], v2 offset:3360
    ds_read_b64_tr_b16 v[14:15], v2 offset:3328
    s_waitcnt lgkmcnt(9)
    v_mfma_f32_32x32x16_bf16 v[88:103], v[16:19], v[148:151], v[88:103]
    v_mov_b32_dpp v84, v83 quad_perm:[1,1,3,3] row_mask:0xf bank_mask:0xf
    v_add_f32_dpp v83, v82, v83 quad_perm:[1,1,3,3] row_mask:0xf bank_mask:0xf
    v_add_f32_dpp v82, v81, v82 quad_perm:[1,1,3,3] row_mask:0xf bank_mask:0xf
    v_add_f32_dpp v81, v80, v81 quad_perm:[1,1,3,3] row_mask:0xf bank_mask:0xf
    ds_read_b64_tr_b16 v[16:17], v2 offset:3488
    ds_read_b64_tr_b16 v[18:19], v2 offset:3456
    s_waitcnt lgkmcnt(8)
    v_mfma_f32_32x32x16_bf16 v[88:103], v[20:23], v[144:147], v[88:103]
    ds_read_b32 v60, v109 offset:4
    ds_read_b128 v[56:59], v4 offset:768
    v_add_f32_dpp v80, v79, v80 quad_perm:[1,1,3,3] row_mask:0xf bank_mask:0xf
    v_add_f32_dpp v79, v78, v79 quad_perm:[1,1,3,3] row_mask:0xf bank_mask:0xf
    v_add_f32_dpp v78, v77, v78 quad_perm:[1,1,3,3] row_mask:0xf bank_mask:0xf
    ds_read_b64_tr_b16 v[20:21], v2 offset:3616
    ds_read_b64_tr_b16 v[22:23], v2 offset:3584
    s_waitcnt lgkmcnt(10)
    v_mfma_f32_32x32x16_bf16 v[88:103], v[24:27], v[140:143], v[88:103]
    v_add_f32_dpp v77, v76, v77 quad_perm:[1,1,3,3] row_mask:0xf bank_mask:0xf
    v_add_f32_dpp v76, v75, v76 quad_perm:[1,1,3,3] row_mask:0xf bank_mask:0xf
    v_add_f32_dpp v75, v74, v75 quad_perm:[1,1,3,3] row_mask:0xf bank_mask:0xf
    v_add_f32_dpp v74, v73, v74 quad_perm:[1,1,3,3] row_mask:0xf bank_mask:0xf
    ds_read_b64_tr_b16 v[24:25], v2 offset:3744
    ds_read_b64_tr_b16 v[26:27], v2 offset:3712
    s_waitcnt lgkmcnt(10)
    v_mfma_f32_32x32x16_bf16 v[88:103], v[8:11], v[136:139], v[88:103]
    v_add_f32_dpp v73, v72, v73 quad_perm:[1,1,3,3] row_mask:0xf bank_mask:0xf
    v_add_f32_dpp v72, v71, v72 quad_perm:[1,1,3,3] row_mask:0xf bank_mask:0xf
    v_add_f32_dpp v71, v70, v71 quad_perm:[1,1,3,3] row_mask:0xf bank_mask:0xf
    v_add_f32_dpp v70, v69, v70 quad_perm:[1,1,3,3] row_mask:0xf bank_mask:0xf
    ds_read_b64_tr_b16 v[8:9], v2 offset:3872
    ds_read_b64_tr_b16 v[10:11], v2 offset:3840
    s_waitcnt lgkmcnt(10)
    v_mfma_f32_32x32x16_bf16 v[88:103], v[12:15], v[132:135], v[88:103]
    s_waitcnt lgkmcnt(6)
    v_readfirstlane_b32 s10, v60
    s_nop 0
    s_cmp_eq_u32 s10, 0
    s_cbranch_scc1 Lcsl_36
Lcok_35:
    v_add_f32 v48, v48, v56
    v_add_f32 v49, v49, v57
    v_add_f32 v50, v50, v58
    ds_read_b64_tr_b16 v[12:13], v2 offset:4000
    ds_read_b64_tr_b16 v[14:15], v2 offset:3968
    v_mfma_f32_32x32x16_bf16 v[88:103], v[16:19], v[128:131], v[88:103]
    v_cvt_pk_bf16_f32 v48, v48, v49
    v_cvt_pk_bf16_f32 v49, v50, v51
    v_cndmask_b32_dpp v50, v54, v64, vcc quad_perm:[0,0,0,0] row_mask:0xf bank_mask:0xf
    v_cndmask_b32_dpp v51, v55, v65, vcc quad_perm:[0,0,0,0] row_mask:0xf bank_mask:0xf
    s_waitcnt lgkmcnt(6)
    v_mfma_f32_32x32x16_bf16 v[88:103], v[20:23], v[124:127], v[88:103]
    v_cndmask_b32_dpp v48, v52, v48, vcc quad_perm:[0,0,0,0] row_mask:0xf bank_mask:0xf
    v_cndmask_b32_dpp v49, v53, v49, vcc quad_perm:[0,0,0,0] row_mask:0xf bank_mask:0xf
    v_add_f32_dpp v69, v68, v69 quad_perm:[1,1,3,3] row_mask:0xf bank_mask:0xf
    v_mov_b32_dpp v86, v84 quad_perm:[2,2,2,2] row_mask:0xf bank_mask:0xf
    s_waitcnt lgkmcnt(4)
    v_mfma_f32_32x32x16_bf16 v[88:103], v[24:27], v[120:123], v[88:103]
    v_mov_b32_dpp v85, v83 quad_perm:[2,2,2,2] row_mask:0xf bank_mask:0xf
    v_add_f32_dpp v84, v82, v84 quad_perm:[2,2,2,2] row_mask:0xf bank_mask:0xf
    s_mov_b64 exec, vcc
    ds_write_b128 v4, v[84:87] offset:1040
    s_mov_b64 exec, 1
    ds_write_b32 v108, v6 offset:8
    s_mov_b64 exec, -1
    v_add_f32_dpp v83, v81, v83 quad_perm:[2,2,2,2] row_mask:0xf bank_mask:0xf
    s_waitcnt lgkmcnt(4)
    v_mfma_f32_32x32x16_bf16 v[88:103], v[8:11], v[116:119], v[88:103]
    v_add_f32_dpp v82, v80, v82 quad_perm:[2,2,2,2] row_mask:0xf bank_mask:0xf
    v_add_f32_dpp v81, v79, v81 quad_perm:[2,2,2,2] row_mask:0xf bank_mask:0xf
    v_add_f32_dpp v80, v78, v80 quad_perm:[2,2,2,2] row_mask:0xf bank_mask:0xf
    v_add_f32_dpp v79, v77, v79 quad_perm:[2,2,2,2] row_mask:0xf bank_mask:0xf
    s_waitcnt lgkmcnt(2)
    v_mfma_f32_32x32x16_bf16 v[88:103], v[12:15], v[112:115], v[88:103]
    v_add_f32_dpp v78, v76, v78 quad_perm:[2,2,2,2] row_mask:0xf bank_mask:0xf
    v_add_f32_dpp v77, v75, v77 quad_perm:[2,2,2,2] row_mask:0xf bank_mask:0xf
    v_add_f32_dpp v76, v74, v76 quad_perm:[2,2,2,2] row_mask:0xf bank_mask:0xf
    v_add_f32_dpp v75, v73, v75 quad_perm:[2,2,2,2] row_mask:0xf bank_mask:0xf
    s_nop 7
    v_mov_b32_dpp v104, v103 quad_perm:[1,1,3,3] row_mask:0xf bank_mask:0xf
    v_add_f32_dpp v103, v102, v103 quad_perm:[1,1,3,3] row_mask:0xf bank_mask:0xf
    v_add_f32_dpp v102, v101, v102 quad_perm:[1,1,3,3] row_mask:0xf bank_mask:0xf
    v_add_f32_dpp v101, v100, v101 quad_perm:[1,1,3,3] row_mask:0xf bank_mask:0xf
    v_add_f32_dpp v100, v99, v100 quad_perm:[1,1,3,3] row_mask:0xf bank_mask:0xf
    v_add_f32_dpp v99, v98, v99 quad_perm:[1,1,3,3] row_mask:0xf bank_mask:0xf
    v_add_f32_dpp v98, v97, v98 quad_perm:[1,1,3,3] row_mask:0xf bank_mask:0xf
    v_add_f32_dpp v97, v96, v97 quad_perm:[1,1,3,3] row_mask:0xf bank_mask:0xf
    v_add_f32_dpp v96, v95, v96 quad_perm:[1,1,3,3] row_mask:0xf bank_mask:0xf
    v_add_f32_dpp v95, v94, v95 quad_perm:[1,1,3,3] row_mask:0xf bank_mask:0xf
    v_add_f32_dpp v94, v93, v94 quad_perm:[1,1,3,3] row_mask:0xf bank_mask:0xf
    v_add_f32_dpp v93, v92, v93 quad_perm:[1,1,3,3] row_mask:0xf bank_mask:0xf
    v_add_f32_dpp v92, v91, v92 quad_perm:[1,1,3,3] row_mask:0xf bank_mask:0xf
    v_add_f32_dpp v91, v90, v91 quad_perm:[1,1,3,3] row_mask:0xf bank_mask:0xf
    v_add_f32_dpp v90, v89, v90 quad_perm:[1,1,3,3] row_mask:0xf bank_mask:0xf
    v_add_f32_dpp v89, v88, v89 quad_perm:[1,1,3,3] row_mask:0xf bank_mask:0xf
    v_mov_b32_dpp v106, v104 quad_perm:[2,2,2,2] row_mask:0xf bank_mask:0xf
    v_mov_b32_dpp v105, v103 quad_perm:[2,2,2,2] row_mask:0xf bank_mask:0xf
    v_add_f32_dpp v104, v102, v104 quad_perm:[2,2,2,2] row_mask:0xf bank_mask:0xf
    s_mov_b64 exec, vcc
    ds_write_b128 v4, v[104:107] offset:1808
    s_mov_b64 exec, -1
    v_add_f32_dpp v74, v72, v74 quad_perm:[2,2,2,2] row_mask:0xf bank_mask:0xf
    v_add_f32_dpp v73, v71, v73 quad_perm:[2,2,2,2] row_mask:0xf bank_mask:0xf
    v_add_f32_dpp v72, v70, v72 quad_perm:[2,2,2,2] row_mask:0xf bank_mask:0xf
    v_add_f32_dpp v71, v69, v71 quad_perm:[2,2,2,2] row_mask:0xf bank_mask:0xf
    v_add_f32_dpp v70, v68, v70 quad_perm:[2,2,2,2] row_mask:0xf bank_mask:0xf
    v_cvt_pk_bf16_f32 v84, v72, v73
    v_cvt_pk_bf16_f32 v85, v74, v75
    v_cvt_pk_bf16_f32 v72, v76, v77
    v_cvt_pk_bf16_f32 v73, v78, v79
    v_cvt_pk_bf16_f32 v74, v80, v81
    v_cvt_pk_bf16_f32 v75, v82, v83
    ds_read_b128 v[76:79], v4 offset:1024
    v_add_f32_dpp v103, v101, v103 quad_perm:[2,2,2,2] row_mask:0xf bank_mask:0xf
    v_add_f32_dpp v102, v100, v102 quad_perm:[2,2,2,2] row_mask:0xf bank_mask:0xf
    v_add_f32_dpp v101, v99, v101 quad_perm:[2,2,2,2] row_mask:0xf bank_mask:0xf
    v_add_f32_dpp v100, v98, v100 quad_perm:[2,2,2,2] row_mask:0xf bank_mask:0xf
    v_add_f32_dpp v99, v97, v99 quad_perm:[2,2,2,2] row_mask:0xf bank_mask:0xf
    v_add_f32_dpp v98, v96, v98 quad_perm:[2,2,2,2] row_mask:0xf bank_mask:0xf
    v_add_f32_dpp v97, v95, v97 quad_perm:[2,2,2,2] row_mask:0xf bank_mask:0xf
    v_add_f32_dpp v96, v94, v96 quad_perm:[2,2,2,2] row_mask:0xf bank_mask:0xf
    v_add_f32_dpp v95, v93, v95 quad_perm:[2,2,2,2] row_mask:0xf bank_mask:0xf
    v_add_f32_dpp v94, v92, v94 quad_perm:[2,2,2,2] row_mask:0xf bank_mask:0xf
    v_add_f32_dpp v93, v91, v93 quad_perm:[2,2,2,2] row_mask:0xf bank_mask:0xf
    v_add_f32_dpp v92, v90, v92 quad_perm:[2,2,2,2] row_mask:0xf bank_mask:0xf
    v_add_f32_dpp v91, v89, v91 quad_perm:[2,2,2,2] row_mask:0xf bank_mask:0xf
    v_add_f32_dpp v90, v88, v90 quad_perm:[2,2,2,2] row_mask:0xf bank_mask:0xf
    v_cvt_pk_bf16_f32 v104, v92, v93
    v_cvt_pk_bf16_f32 v105, v94, v95
    v_cvt_pk_bf16_f32 v92, v96, v97
    v_cvt_pk_bf16_f32 v93, v98, v99
    v_cvt_pk_bf16_f32 v94, v100, v101
    v_cvt_pk_bf16_f32 v95, v102, v103
    ds_read_b32 v100, v109 offset:12
    ds_read_b128 v[96:99], v4 offset:1792
    s_waitcnt lgkmcnt(2)
    v_add_f32 v68, v68, v76
    v_add_f32 v69, v69, v77
    v_add_f32 v70, v70, v78
    v_cvt_pk_bf16_f32 v68, v68, v69
    v_cvt_pk_bf16_f32 v69, v70, v71
    v_cndmask_b32_dpp v70, v74, v84, vcc quad_perm:[0,0,0,0] row_mask:0xf bank_mask:0xf
    v_cndmask_b32_dpp v71, v75, v85, vcc quad_perm:[0,0,0,0] row_mask:0xf bank_mask:0xf
    v_cndmask_b32_dpp v68, v72, v68, vcc quad_perm:[0,0,0,0] row_mask:0xf bank_mask:0xf
    v_cndmask_b32_dpp v69, v73, v69, vcc quad_perm:[0,0,0,0] row_mask:0xf bank_mask:0xf
    s_waitcnt lgkmcnt(0)
    v_readfirstlane_b32 s10, v100
    s_nop 0
    s_cmp_eq_u32 s10, 0
    s_cbranch_scc1 Lcsl_38
Lcok_37:
    v_add_f32 v88, v88, v96
    v_add_f32 v89, v89, v97
    v_add_f32 v90, v90, v98
    v_cvt_pk_bf16_f32 v88, v88, v89
    v_cvt_pk_bf16_f32 v89, v90, v91
    v_cndmask_b32_dpp v90, v94, v104, vcc quad_perm:[0,0,0,0] row_mask:0xf bank_mask:0xf
    v_cndmask_b32_dpp v91, v95, v105, vcc quad_perm:[0,0,0,0] row_mask:0xf bank_mask:0xf
    v_cndmask_b32_dpp v88, v92, v88, vcc quad_perm:[0,0,0,0] row_mask:0xf bank_mask:0xf
    v_cndmask_b32_dpp v89, v93, v89, vcc quad_perm:[0,0,0,0] row_mask:0xf bank_mask:0xf
    s_mov_b64 exec, s[12:13]
    buffer_store_dwordx4 v[28:31], v5, s[64:67], s89 offen offset:0 sc1
    s_mov_b64 exec, -1
    s_mov_b64 exec, s[12:13]
    buffer_store_dwordx4 v[48:51], v5, s[64:67], s89 offen offset:1536 sc1
    s_mov_b64 exec, -1
    s_mov_b64 exec, s[12:13]
    buffer_store_dwordx4 v[68:71], v5, s[64:67], s89 offen offset:2048 sc1
    s_mov_b64 exec, -1
    s_mov_b64 exec, s[12:13]
    buffer_store_dwordx4 v[88:91], v5, s[64:67], s89 offen offset:3584 sc1
    s_mov_b64 exec, -1
    s_branch L_g2c
L_st0:
    s_branch L_stret
L_set1:
    ds_read_b64_tr_b16 v[8:9], v2 offset:32
    ds_read_b64_tr_b16 v[10:11], v2 offset:0
    ds_read_b128 v[140:143], v3 offset:896
    ds_read_b128 v[156:159], v3 offset:1408
    ds_read_b128 v[204:207], v3 offset:2944
    ds_read_b128 v[220:223], v3 offset:3456
    ds_read_b64_tr_b16 v[12:13], v2 offset:160
    ds_read_b64_tr_b16 v[14:15], v2 offset:128
    ds_read_b128 v[136:139], v3 offset:768
    ds_read_b128 v[152:155], v3 offset:1280
    ds_read_b128 v[200:203], v3 offset:2816
    s_waitcnt lgkmcnt(8)
    v_mfma_f32_32x32x16_bf16 v[28:43], v[8:11], v[140:143], 0
    ds_read_b128 v[216:219], v3 offset:3328
    s_waitcnt lgkmcnt(8)
    v_mfma_f32_32x32x16_bf16 v[48:63], v[8:11], v[156:159], 0
    ds_read_b64_tr_b16 v[16:17], v2 offset:288
    ds_read_b64_tr_b16 v[18:19], v2 offset:256
    ds_read_b128 v[132:135], v3 offset:640
    s_waitcnt lgkmcnt(10)
    v_mfma_f32_32x32x16_bf16 v[68:83], v[8:11], v[204:207], 0
    ds_read_b128 v[148:151], v3 offset:1152
    s_waitcnt lgkmcnt(10)
    v_mfma_f32_32x32x16_bf16 v[88:103], v[8:11], v[220:223], 0
    ds_read_b128 v[196:199], v3 offset:2688
    s_waitcnt lgkmcnt(8)
    v_mfma_f32_32x32x16_bf16 v[28:43], v[12:15], v[136:139], v[28:43]
    ds_read_b128 v[212:215], v3 offset:3200
    s_waitcnt lgkmcnt(8)
    v_mfma_f32_32x32x16_bf16 v[48:63], v[12:15], v[152:155], v[48:63]
    ds_read_b64_tr_b16 v[20:21], v2 offset:416
    ds_read_b64_tr_b16 v[22:23], v2 offset:384
    ds_read_b128 v[128:131], v3 offset:512
    s_waitcnt lgkmcnt(10)
    v_mfma_f32_32x32x16_bf16 v[68:83], v[12:15], v[200:203], v[68:83]
    ds_read_b128 v[144:147], v3 offset:1024
    s_waitcnt lgkmcnt(10)
    v_mfma_f32_32x32x16_bf16 v[88:103], v[12:15], v[216:219], v[88:103]
    ds_read_b128 v[192:195], v3 offset:2560
    s_waitcnt lgkmcnt(8)
    v_mfma_f32_32x32x16_bf16 v[28:43], v[16:19], v[132:135], v[28:43]
    ds_read_b128 v[208:211], v3 offset:3072
    s_waitcnt lgkmcnt(8)
    v_mfma_f32_32x32x16_bf16 v[48:63], v[16:19], v[148:151], v[48:63]
    ds_read_b64_tr_b16 v[24:25], v2 offset:544
    ds_read_b64_tr_b16 v[26:27], v2 offset:512
    ds_read_b128 v[124:127], v3 offset:384
    s_waitcnt lgkmcnt(10)
    v_mfma_f32_32x32x16_bf16 v[68:83], v[16:19], v[196:199], v[68:83]
    s_waitcnt lgkmcnt(9)
    v_mfma_f32_32x32x16_bf16 v[88:103], v[16:19], v[212:215], v[88:103]
    ds_read_b128 v[188:191], v3 offset:2432
    s_waitcnt lgkmcnt(7)
    v_mfma_f32_32x32x16_bf16 v[28:43], v[20:23], v[128:131], v[28:43]
    s_waitcnt lgkmcnt(6)
    v_mfma_f32_32x32x16_bf16 v[48:63], v[20:23], v[144:147], v[48:63]
    ds_read_b64_tr_b16 v[8:9], v2 offset:672
    ds_read_b64_tr_b16 v[10:11], v2 offset:640
    ds_read_b128 v[120:123], v3 offset:256
    s_waitcnt lgkmcnt(8)
    v_mfma_f32_32x32x16_bf16 v[68:83], v[20:23], v[192:195], v[68:83]
    s_waitcnt lgkmcnt(7)
    v_mfma_f32_32x32x16_bf16 v[88:103], v[20:23], v[208:211], v[88:103]
    ds_read_b128 v[184:187], v3 offset:2304
    s_waitcnt lgkmcnt(5)
    v_mfma_f32_32x32x16_bf16 v[28:43], v[24:27], v[124:127], v[28:43]
    v_mfma_f32_32x32x16_bf16 v[48:63], v[24:27], v[140:143], v[48:63]
    ds_read_b64_tr_b16 v[12:13], v2 offset:800
    ds_read_b64_tr_b16 v[14:15], v2 offset:768
    ds_read_b128 v[116:119], v3 offset:128
    s_waitcnt lgkmcnt(7)
    v_mfma_f32_32x32x16_bf16 v[68:83], v[24:27], v[188:191], v[68:83]
    v_mfma_f32_32x32x16_bf16 v[88:103], v[24:27], v[204:207], v[88:103]
    ds_read_b128 v[180:183], v3 offset:2176
    s_waitcnt lgkmcnt(5)
    v_mfma_f32_32x32x16_bf16 v[28:43], v[8:11], v[120:123], v[28:43]
    v_mfma_f32_32x32x16_bf16 v[48:63], v[8:11], v[136:139], v[48:63]
    ds_read_b64_tr_b16 v[16:17], v2 offset:928
    ds_read_b64_tr_b16 v[18:19], v2 offset:896
    ds_read_b128 v[112:115], v3 offset:0
    s_waitcnt lgkmcnt(7)
    v_mfma_f32_32x32x16_bf16 v[68:83], v[8:11], v[184:187], v[68:83]
    v_mfma_f32_32x32x16_bf16 v[88:103], v[8:11], v[200:203], v[88:103]
    ds_read_b128 v[176:179], v3 offset:2048
    s_waitcnt lgkmcnt(5)
    v_mfma_f32_32x32x16_bf16 v[28:43], v[12:15], v[116:119], v[28:43]
    v_mfma_f32_32x32x16_bf16 v[48:63], v[12:15], v[132:135], v[48:63]
    ds_read_b64_tr_b16 v[20:21], v2 offset:1056
    ds_read_b64_tr_b16 v[22:23], v2 offset:1024
    s_waitcnt lgkmcnt(6)
    v_mfma_f32_32x32x16_bf16 v[68:83], v[12:15], v[180:183], v[68:83]
    ds_read_b128 v[172:175], v3 offset:1920
    v_mfma_f32_32x32x16_bf16 v[88:103], v[12:15], v[196:199], v[88:103]
    s_waitcnt lgkmcnt(4)
    v_mfma_f32_32x32x16_bf16 v[28:43], v[16:19], v[112:115], v[28:43]
    ds_read_b64_tr_b16 v[24:25], v2 offset:1184
    ds_read_b64_tr_b16 v[26:27], v2 offset:1152
    v_mfma_f32_32x32x16_bf16 v[48:63], v[16:19], v[128:131], v[48:63]
    ds_read_b128 v[168:171], v3 offset:1792
    s_waitcnt lgkmcnt(6)
    v_mfma_f32_32x32x16_bf16 v[68:83], v[16:19], v[176:179], v[68:83]
    v_mfma_f32_32x32x16_bf16 v[88:103], v[16:19], v[192:195], v[88:103]
    s_nop 4
    v_mov_b32_dpp v44, v43 quad_perm:[1,1,3,3] row_mask:0xf bank_mask:0xf
    v_add_f32_dpp v43, v42, v43 quad_perm:[1,1,3,3] row_mask:0xf bank_mask:0xf
    v_add_f32_dpp v42, v41, v42 quad_perm:[1,1,3,3] row_mask:0xf bank_mask:0xf
    v_add_f32_dpp v41, v40, v41 quad_perm:[1,1,3,3] row_mask:0xf bank_mask:0xf
    ds_read_b64_tr_b16 v[8:9], v2 offset:1312
    ds_read_b64_tr_b16 v[10:11], v2 offset:1280
    s_waitcnt lgkmcnt(6)
    v_mfma_f32_32x32x16_bf16 v[48:63], v[20:23], v[124:127], v[48:63]
    v_add_f32_dpp v40, v39, v40 quad_perm:[1,1,3,3] row_mask:0xf bank_mask:0xf
    v_add_f32_dpp v39, v38, v39 quad_perm:[1,1,3,3] row_mask:0xf bank_mask:0xf
    v_add_f32_dpp v38, v37, v38 quad_perm:[1,1,3,3] row_mask:0xf bank_mask:0xf
    v_add_f32_dpp v37, v36, v37 quad_perm:[1,1,3,3] row_mask:0xf bank_mask:0xf
    ds_read_b128 v[164:167], v3 offset:1664
    s_waitcnt lgkmcnt(6)
    v_mfma_f32_32x32x16_bf16 v[68:83], v[20:23], v[172:175], v[68:83]
    v_add_f32_dpp v36, v35, v36 quad_perm:[1,1,3,3] row_mask:0xf bank_mask:0xf
    v_add_f32_dpp v35, v34, v35 quad_perm:[1,1,3,3] row_mask:0xf bank_mask:0xf
    v_add_f32_dpp v34, v33, v34 quad_perm:[1,1,3,3] row_mask:0xf bank_mask:0xf
    v_add_f32_dpp v33, v32, v33 quad_perm:[1,1,3,3] row_mask:0xf bank_mask:0xf
    v_mfma_f32_32x32x16_bf16 v[88:103], v[20:23], v[188:191], v[88:103]
    v_add_f32_dpp v32, v31, v32 quad_perm:[1,1,3,3] row_mask:0xf bank_mask:0xf
    v_add_f32_dpp v31, v30, v31 quad_perm:[1,1,3,3] row_mask:0xf bank_mask:0xf
    v_add_f32_dpp v30, v29, v30 quad_perm:[1,1,3,3] row_mask:0xf bank_mask:0xf
    v_add_f32_dpp v29, v28, v29 quad_perm:[1,1,3,3] row_mask:0xf bank_mask:0xf
    ds_read_b64_tr_b16 v[12:13], v2 offset:1440
    ds_read_b64_tr_b16 v[14:15], v2 offset:1408
    s_waitcnt lgkmcnt(6)
    v_mfma_f32_32x32x16_bf16 v[48:63], v[24:27], v[120:123], v[48:63]
    v_mov_b32_dpp v46, v44 quad_perm:[2,2,2,2] row_mask:0xf bank_mask:0xf
    v_mov_b32_dpp v45, v43 quad_perm:[2,2,2,2] row_mask:0xf bank_mask:0xf
    v_add_f32_dpp v44, v42, v44 quad_perm:[2,2,2,2] row_mask:0xf bank_mask:0xf
    s_mov_b64 exec, vcc
    ds_write_b128 v4, v[44:47] offset:272
    s_mov_b64 exec, -1
    ds_read_b128 v[160:163], v3 offset:1536
    s_waitcnt lgkmcnt(7)
    v_mfma_f32_32x32x16_bf16 v[68:83], v[24:27], v[168:171], v[68:83]
    v_add_f32_dpp v43, v41, v43 quad_perm:[2,2,2,2] row_mask:0xf bank_mask:0xf
    v_add_f32_dpp v42, v40, v42 quad_perm:[2,2,2,2] row_mask:0xf bank_mask:0xf
    v_add_f32_dpp v41, v39, v41 quad_perm:[2,2,2,2] row_mask:0xf bank_mask:0xf
    v_add_f32_dpp v40, v38, v40 quad_perm:[2,2,2,2] row_mask:0xf bank_mask:0xf
    v_mfma_f32_32x32x16_bf16 v[88:103], v[24:27], v[184:187], v[88:103]
    v_add_f32_dpp v39, v37, v39 quad_perm:[2,2,2,2] row_mask:0xf bank_mask:0xf
    v_add_f32_dpp v38, v36, v38 quad_perm:[2,2,2,2] row_mask:0xf bank_mask:0xf
    v_add_f32_dpp v37, v35, v37 quad_perm:[2,2,2,2] row_mask:0xf bank_mask:0xf
    v_add_f32_dpp v36, v34, v36 quad_perm:[2,2,2,2] row_mask:0xf bank_mask:0xf
    ds_read_b64_tr_b16 v[16:17], v2 offset:1568
    ds_read_b64_tr_b16 v[18:19], v2 offset:1536
    s_waitcnt lgkmcnt(7)
    v_mfma_f32_32x32x16_bf16 v[48:63], v[8:11], v[116:119], v[48:63]
    v_add_f32_dpp v35, v33, v35 quad_perm:[2,2,2,2] row_mask:0xf bank_mask:0xf
    v_add_f32_dpp v34, v32, v34 quad_perm:[2,2,2,2] row_mask:0xf bank_mask:0xf
    v_add_f32_dpp v33, v31, v33 quad_perm:[2,2,2,2] row_mask:0xf bank_mask:0xf
    v_add_f32_dpp v32, v30, v32 quad_perm:[2,2,2,2] row_mask:0xf bank_mask:0xf
    s_waitcnt lgkmcnt(6)
    v_mfma_f32_32x32x16_bf16 v[68:83], v[8:11], v[164:167], v[68:83]
    v_add_f32_dpp v31, v29, v31 quad_perm:[2,2,2,2] row_mask:0xf bank_mask:0xf
    v_add_f32_dpp v30, v28, v30 quad_perm:[2,2,2,2] row_mask:0xf bank_mask:0xf
    v_cvt_pk_bf16_f32 v44, v32, v33
    v_cvt_pk_bf16_f32 v45, v34, v35
    ds_read_b64_tr_b16 v[20:21], v2 offset:1696
    ds_read_b64_tr_b16 v[22:23], v2 offset:1664
    v_mfma_f32_32x32x16_bf16 v[88:103], v[8:11], v[180:183], v[88:103]
    v_cvt_pk_bf16_f32 v32, v36, v37
    v_cvt_pk_bf16_f32 v33, v38, v39
    v_cvt_pk_bf16_f32 v34, v40, v41
    v_cvt_pk_bf16_f32 v35, v42, v43
    s_waitcnt lgkmcnt(6)
    v_mfma_f32_32x32x16_bf16 v[48:63], v[12:15], v[112:115], v[48:63]
    ds_read_b32 v40, v109 offset:0
    ds_read_b128 v[36:39], v4 offset:256
    ds_read_b64_tr_b16 v[24:25], v2 offset:1824
    ds_read_b64_tr_b16 v[26:27], v2 offset:1792
    s_waitcnt lgkmcnt(8)
    v_mfma_f32_32x32x16_bf16 v[68:83], v[12:15], v[160:163], v[68:83]
    v_mfma_f32_32x32x16_bf16 v[88:103], v[12:15], v[176:179], v[88:103]
    ds_read_b64_tr_b16 v[8:9], v2 offset:1952
    ds_read_b64_tr_b16 v[10:11], v2 offset:1920
    s_waitcnt lgkmcnt(8)
    v_mfma_f32_32x32x16_bf16 v[68:83], v[16:19], v[156:159], v[68:83]
    s_waitcnt lgkmcnt(4)
    v_readfirstlane_b32 s10, v40
    s_nop 0
    s_cmp_eq_u32 s10, 0
    s_cbranch_scc1 Lcsl_40
Lcok_39:
    v_add_f32 v28, v28, v36
    v_add_f32 v29, v29, v37
    v_add_f32 v30, v30, v38
    v_mfma_f32_32x32x16_bf16 v[88:103], v[16:19], v[172:175], v[88:103]
    v_cvt_pk_bf16_f32 v28, v28, v29
    v_cvt_pk_bf16_f32 v29, v30, v31
    v_cndmask_b32_dpp v30, v34, v44, vcc quad_perm:[0,0,0,0] row_mask:0xf bank_mask:0xf
    v_cndmask_b32_dpp v31, v35, v45, vcc quad_perm:[0,0,0,0] row_mask:0xf bank_mask:0xf
    ds_read_b64_tr_b16 v[12:13], v2 offset:2080
    ds_read_b64_tr_b16 v[14:15], v2 offset:2048
    v_mfma_f32_32x32x16_bf16 v[68:83], v[20:23], v[152:155], v[68:83]
    v_cndmask_b32_dpp v28, v32, v28, vcc quad_perm:[0,0,0,0] row_mask:0xf bank_mask:0xf
    v_cndmask_b32_dpp v29, v33, v29, vcc quad_perm:[0,0,0,0] row_mask:0xf bank_mask:0xf
    v_mov_b32_dpp v64, v63 quad_perm:[1,1,3,3] row_mask:0xf bank_mask:0xf
    v_add_f32_dpp v63, v62, v63 quad_perm:[1,1,3,3] row_mask:0xf bank_mask:0xf
    v_mfma_f32_32x32x16_bf16 v[88:103], v[20:23], v[168:171], v[88:103]
    v_add_f32_dpp v62, v61, v62 quad_perm:[1,1,3,3] row_mask:0xf bank_mask:0xf
    v_add_f32_dpp v61, v60, v61 quad_perm:[1,1,3,3] row_mask:0xf bank_mask:0xf
    v_add_f32_dpp v60, v59, v60 quad_perm:[1,1,3,3] row_mask:0xf bank_mask:0xf
    v_add_f32_dpp v59, v58, v59 quad_perm:[1,1,3,3] row_mask:0xf bank_mask:0xf
    ds_read_b64_tr_b16 v[16:17], v2 offset:2208
    ds_read_b64_tr_b16 v[18:19], v2 offset:2176
    s_waitcnt lgkmcnt(6)
    v_mfma_f32_32x32x16_bf16 v[68:83], v[24:27], v[148:151], v[68:83]
    v_add_f32_dpp v58, v57, v58 quad_perm:[1,1,3,3] row_mask:0xf bank_mask:0xf
    v_add_f32_dpp v57, v56, v57 quad_perm:[1,1,3,3] row_mask:0xf bank_mask:0xf
    v_add_f32_dpp v56, v55, v56 quad_perm:[1,1,3,3] row_mask:0xf bank_mask:0xf
    v_add_f32_dpp v55, v54, v55 quad_perm:[1,1,3,3] row_mask:0xf bank_mask:0xf
    v_mfma_f32_32x32x16_bf16 v[88:103], v[24:27], v[164:167], v[88:103]
    v_add_f32_dpp v54, v53, v54 quad_perm:[1,1,3,3] row_mask:0xf bank_mask:0xf
    v_add_f32_dpp v53, v52, v53 quad_perm:[1,1,3,3] row_mask:0xf bank_mask:0xf
    v_add_f32_dpp v52, v51, v52 quad_perm:[1,1,3,3] row_mask:0xf bank_mask:0xf
    v_add_f32_dpp v51, v50, v51 quad_perm:[1,1,3,3] row_mask:0xf bank_mask:0xf
    ds_read_b64_tr_b16 v[20:21], v2 offset:2336
    ds_read_b64_tr_b16 v[22:23], v2 offset:2304
    s_waitcnt lgkmcnt(6)
    v_mfma_f32_32x32x16_bf16 v[68:83], v[8:11], v[144:147], v[68:83]
    v_add_f32_dpp v50, v49, v50 quad_perm:[1,1,3,3] row_mask:0xf bank_mask:0xf
    v_add_f32_dpp v49, v48, v49 quad_perm:[1,1,3,3] row_mask:0xf bank_mask:0xf
    v_mov_b32_dpp v66, v64 quad_perm:[2,2,2,2] row_mask:0xf bank_mask:0xf
    v_mov_b32_dpp v65, v63 quad_perm:[2,2,2,2] row_mask:0xf bank_mask:0xf
    v_mfma_f32_32x32x16_bf16 v[88:103], v[8:11], v[160:163], v[88:103]
    v_add_f32_dpp v64, v62, v64 quad_perm:[2,2,2,2] row_mask:0xf bank_mask:0xf
    s_mov_b64 exec, vcc
    ds_write_b128 v4, v[64:67] offset:528
    s_mov_b64 exec, 1
    ds_write_b32 v108, v6 offset:4
    s_mov_b64 exec, -1
    v_add_f32_dpp v63, v61, v63 quad_perm:[2,2,2,2] row_mask:0xf bank_mask:0xf
    v_add_f32_dpp v62, v60, v62 quad_perm:[2,2,2,2] row_mask:0xf bank_mask:0xf
    ds_read_b64_tr_b16 v[24:25], v2 offset:2464
    ds_read_b64_tr_b16 v[26:27], v2 offset:2432
    s_waitcnt lgkmcnt(8)
    v_mfma_f32_32x32x16_bf16 v[68:83], v[12:15], v[140:143], v[68:83]
    v_add_f32_dpp v61, v59, v61 quad_perm:[2,2,2,2] row_mask:0xf bank_mask:0xf
    v_add_f32_dpp v60, v58, v60 quad_perm:[2,2,2,2] row_mask:0xf bank_mask:0xf
    v_add_f32_dpp v59, v57, v59 quad_perm:[2,2,2,2] row_mask:0xf bank_mask:0xf
    v_add_f32_dpp v58, v56, v58 quad_perm:[2,2,2,2] row_mask:0xf bank_mask:0xf
    v_mfma_f32_32x32x16_bf16 v[88:103], v[12:15], v[156:159], v[88:103]
    v_add_f32_dpp v57, v55, v57 quad_perm:[2,2,2,2] row_mask:0xf bank_mask:0xf
    v_add_f32_dpp v56, v54, v56 quad_perm:[2,2,2,2] row_mask:0xf bank_mask:0xf
    v_add_f32_dpp v55, v53, v55 quad_perm:[2,2,2,2] row_mask:0xf bank_mask:0xf
    v_add_f32_dpp v54, v52, v54 quad_perm:[2,2,2,2] row_mask:0xf bank_mask:0xf
    ds_read_b64_tr_b16 v[8:9], v2 offset:2592
    ds_read_b64_tr_b16 v[10:11], v2 offset:2560
    s_waitcnt lgkmcnt(8)
    v_mfma_f32_32x32x16_bf16 v[68:83], v[16:19], v[136:139], v[68:83]
    v_add_f32_dpp v53, v51, v53 quad_perm:[2,2,2,2] row_mask:0xf bank_mask:0xf
    v_add_f32_dpp v52, v50, v52 quad_perm:[2,2,2,2] row_mask:0xf bank_mask:0xf
    v_add_f32_dpp v51, v49, v51 quad_perm:[2,2,2,2] row_mask:0xf bank_mask:0xf
    v_add_f32_dpp v50, v48, v50 quad_perm:[2,2,2,2] row_mask:0xf bank_mask:0xf
    v_mfma_f32_32x32x16_bf16 v[88:103], v[16:19], v[152:155], v[88:103]
    v_cvt_pk_bf16_f32 v64, v52, v53
    v_cvt_pk_bf16_f32 v65, v54, v55
    v_cvt_pk_bf16_f32 v52, v56, v57
    v_cvt_pk_bf16_f32 v53, v58, v59
    ds_read_b64_tr_b16 v[12:13], v2 offset:2720
    ds_read_b64_tr_b16 v[14:15], v2 offset:2688
    s_waitcnt lgkmcnt(8)
    v_mfma_f32_32x32x16_bf16 v[68:83], v[20:23], v[132:135], v[68:83]
    v_cvt_pk_bf16_f32 v54, v60, v61
    v_cvt_pk_bf16_f32 v55, v62, v63
    ds_read_b128 v[56:59], v4 offset:512
    v_mfma_f32_32x32x16_bf16 v[88:103], v[20:23], v[148:151], v[88:103]
    ds_read_b64_tr_b16 v[16:17], v2 offset:2848
    ds_read_b64_tr_b16 v[18:19], v2 offset:2816
    s_waitcnt lgkmcnt(7)
    v_mfma_f32_32x32x16_bf16 v[68:83], v[24:27], v[128:131], v[68:83]
    v_mfma_f32_32x32x16_bf16 v[88:103], v[24:27], v[144:147], v[88:103]
    s_waitcnt lgkmcnt(2)
    v_add_f32 v48, v48, v56
    v_add_f32 v49, v49, v57
    v_add_f32 v50, v50, v58
    ds_read_b64_tr_b16 v[20:21], v2 offset:2976
    ds_read_b64_tr_b16 v[22:23], v2 offset:2944
    v_mfma_f32_32x32x16_bf16 v[68:83], v[8:11], v[124:127], v[68:83]
    v_cvt_pk_bf16_f32 v48, v48, v49
    v_cvt_pk_bf16_f32 v49, v50, v51
    v_cndmask_b32_dpp v50, v54, v64, vcc quad_perm:[0,0,0,0] row_mask:0xf bank_mask:0xf
    v_cndmask_b32_dpp v51, v55, v65, vcc quad_perm:[0,0,0,0] row_mask:0xf bank_mask:0xf
    v_mfma_f32_32x32x16_bf16 v[88:103], v[8:11], v[140:143], v[88:103]
    v_cndmask_b32_dpp v48, v52, v48, vcc quad_perm:[0,0,0,0] row_mask:0xf bank_mask:0xf
    v_cndmask_b32_dpp v49, v53, v49, vcc quad_perm:[0,0,0,0] row_mask:0xf bank_mask:0xf
    ds_read_b64_tr_b16 v[24:25], v2 offset:3104
    ds_read_b64_tr_b16 v[26:27], v2 offset:3072
    v_mfma_f32_32x32x16_bf16 v[68:83], v[12:15], v[120:123], v[68:83]
    ds_read_b64_tr_b16 v[8:9], v2 offset:3232
    ds_read_b64_tr_b16 v[10:11], v2 offset:3200
    v_mfma_f32_32x32x16_bf16 v[88:103], v[12:15], v[136:139], v[88:103]
    ds_read_b64_tr_b16 v[12:13], v2 offset:3360
    ds_read_b64_tr_b16 v[14:15], v2 offset:3328
    s_waitcnt lgkmcnt(8)
    v_mfma_f32_32x32x16_bf16 v[68:83], v[16:19], v[116:119], v[68:83]
    v_mfma_f32_32x32x16_bf16 v[88:103], v[16:19], v[132:135], v[88:103]
    ds_read_b64_tr_b16 v[16:17], v2 offset:3488
    ds_read_b64_tr_b16 v[18:19], v2 offset:3456
    s_waitcnt lgkmcnt(8)
    v_mfma_f32_32x32x16_bf16 v[68:83], v[20:23], v[112:115], v[68:83]
    v_mfma_f32_32x32x16_bf16 v[88:103], v[20:23], v[128:131], v[88:103]
    s_waitcnt lgkmcnt(6)
    v_mfma_f32_32x32x16_bf16 v[88:103], v[24:27], v[124:127], v[88:103]
    s_waitcnt lgkmcnt(4)
    v_mfma_f32_32x32x16_bf16 v[88:103], v[8:11], v[120:123], v[88:103]
    s_nop 6
    v_mov_b32_dpp v84, v83 quad_perm:[1,1,3,3] row_mask:0xf bank_mask:0xf
    v_add_f32_dpp v83, v82, v83 quad_perm:[1,1,3,3] row_mask:0xf bank_mask:0xf
    v_add_f32_dpp v82, v81, v82 quad_perm:[1,1,3,3] row_mask:0xf bank_mask:0xf
    v_add_f32_dpp v81, v80, v81 quad_perm:[1,1,3,3] row_mask:0xf bank_mask:0xf
    s_waitcnt lgkmcnt(2)
    v_mfma_f32_32x32x16_bf16 v[88:103], v[12:15], v[116:119], v[88:103]
    v_add_f32_dpp v80, v79, v80 quad_perm:[1,1,3,3] row_mask:0xf bank_mask:0xf
    v_add_f32_dpp v79, v78, v79 quad_perm:[1,1,3,3] row_mask:0xf bank_mask:0xf
    v_add_f32_dpp v78, v77, v78 quad_perm:[1,1,3,3] row_mask:0xf bank_mask:0xf
    v_add_f32_dpp v77, v76, v77 quad_perm:[1,1,3,3] row_mask:0xf bank_mask:0xf
    s_waitcnt lgkmcnt(0)
    v_mfma_f32_32x32x16_bf16 v[88:103], v[16:19], v[112:115], v[88:103]
    v_add_f32_dpp v76, v75, v76 quad_perm:[1,1,3,3] row_mask:0xf bank_mask:0xf
    v_add_f32_dpp v75, v74, v75 quad_perm:[1,1,3,3] row_mask:0xf bank_mask:0xf
    v_add_f32_dpp v74, v73, v74 quad_perm:[1,1,3,3] row_mask:0xf bank_mask:0xf
    v_add_f32_dpp v73, v72, v73 quad_perm:[1,1,3,3] row_mask:0xf bank_mask:0xf
    v_add_f32_dpp v72, v71, v72 quad_perm:[1,1,3,3] row_mask:0xf bank_mask:0xf
    v_add_f32_dpp v71, v70, v71 quad_perm:[1,1,3,3] row_mask:0xf bank_mask:0xf
    v_add_f32_dpp v70, v69, v70 quad_perm:[1,1,3,3] row_mask:0xf bank_mask:0xf
    v_add_f32_dpp v69, v68, v69 quad_perm:[1,1,3,3] row_mask:0xf bank_mask:0xf
    v_mov_b32_dpp v86, v84 quad_perm:[2,2,2,2] row_mask:0xf bank_mask:0xf
    v_mov_b32_dpp v85, v83 quad_perm:[2,2,2,2] row_mask:0xf bank_mask:0xf
    v_add_f32_dpp v84, v82, v84 quad_perm:[2,2,2,2] row_mask:0xf bank_mask:0xf
    s_mov_b64 exec, vcc
    ds_write_b128 v4, v[84:87] offset:1296
    s_mov_b64 exec, -1
    v_mov_b32_dpp v104, v103 quad_perm:[1,1,3,3] row_mask:0xf bank_mask:0xf
    v_add_f32_dpp v103, v102, v103 quad_perm:[1,1,3,3] row_mask:0xf bank_mask:0xf
    v_add_f32_dpp v102, v101, v102 quad_perm:[1,1,3,3] row_mask:0xf bank_mask:0xf
    v_add_f32_dpp v101, v100, v101 quad_perm:[1,1,3,3] row_mask:0xf bank_mask:0xf
    v_add_f32_dpp v100, v99, v100 quad_perm:[1,1,3,3] row_mask:0xf bank_mask:0xf
    v_add_f32_dpp v99, v98, v99 quad_perm:[1,1,3,3] row_mask:0xf bank_mask:0xf
    v_add_f32_dpp v98, v97, v98 quad_perm:[1,1,3,3] row_mask:0xf bank_mask:0xf
    v_add_f32_dpp v97, v96, v97 quad_perm:[1,1,3,3] row_mask:0xf bank_mask:0xf
    v_add_f32_dpp v96, v95, v96 quad_perm:[1,1,3,3] row_mask:0xf bank_mask:0xf
    v_add_f32_dpp v95, v94, v95 quad_perm:[1,1,3,3] row_mask:0xf bank_mask:0xf
    v_add_f32_dpp v94, v93, v94 quad_perm:[1,1,3,3] row_mask:0xf bank_mask:0xf
    v_add_f32_dpp v93, v92, v93 quad_perm:[1,1,3,3] row_mask:0xf bank_mask:0xf
    v_add_f32_dpp v92, v91, v92 quad_perm:[1,1,3,3] row_mask:0xf bank_mask:0xf
    v_add_f32_dpp v91, v90, v91 quad_perm:[1,1,3,3] row_mask:0xf bank_mask:0xf
    v_add_f32_dpp v90, v89, v90 quad_perm:[1,1,3,3] row_mask:0xf bank_mask:0xf
    v_add_f32_dpp v89, v88, v89 quad_perm:[1,1,3,3] row_mask:0xf bank_mask:0xf
    v_mov_b32_dpp v106, v104 quad_perm:[2,2,2,2] row_mask:0xf bank_mask:0xf
    v_mov_b32_dpp v105, v103 quad_perm:[2,2,2,2] row_mask:0xf bank_mask:0xf
    v_add_f32_dpp v104, v102, v104 quad_perm:[2,2,2,2] row_mask:0xf bank_mask:0xf
    s_mov_b64 exec, vcc
    ds_write_b128 v4, v[104:107] offset:1552
    s_mov_b64 exec, 1
    ds_write_b32 v108, v6 offset:12
    s_mov_b64 exec, -1
    v_add_f32_dpp v83, v81, v83 quad_perm:[2,2,2,2] row_mask:0xf bank_mask:0xf
    v_add_f32_dpp v82, v80, v82 quad_perm:[2,2,2,2] row_mask:0xf bank_mask:0xf
    v_add_f32_dpp v81, v79, v81 quad_perm:[2,2,2,2] row_mask:0xf bank_mask:0xf
    v_add_f32_dpp v80, v78, v80 quad_perm:[2,2,2,2] row_mask:0xf bank_mask:0xf
    v_add_f32_dpp v79, v77, v79 quad_perm:[2,2,2,2] row_mask:0xf bank_mask:0xf
    v_add_f32_dpp v78, v76, v78 quad_perm:[2,2,2,2] row_mask:0xf bank_mask:0xf
    v_add_f32_dpp v77, v75, v77 quad_perm:[2,2,2,2] row_mask:0xf bank_mask:0xf
    v_add_f32_dpp v76, v74, v76 quad_perm:[2,2,2,2] row_mask:0xf bank_mask:0xf
    v_add_f32_dpp v75, v73, v75 quad_perm:[2,2,2,2] row_mask:0xf bank_mask:0xf
    v_add_f32_dpp v74, v72, v74 quad_perm:[2,2,2,2] row_mask:0xf bank_mask:0xf
    v_add_f32_dpp v73, v71, v73 quad_perm:[2,2,2,2] row_mask:0xf bank_mask:0xf
    v_add_f32_dpp v72, v70, v72 quad_perm:[2,2,2,2] row_mask:0xf bank_mask:0xf
    v_add_f32_dpp v71, v69, v71 quad_perm:[2,2,2,2] row_mask:0xf bank_mask:0xf
    v_add_f32_dpp v70, v68, v70 quad_perm:[2,2,2,2] row_mask:0xf bank_mask:0xf
    v_cvt_pk_bf16_f32 v84, v72, v73
    v_cvt_pk_bf16_f32 v85, v74, v75
    v_cvt_pk_bf16_f32 v72, v76, v77
    v_cvt_pk_bf16_f32 v73, v78, v79
    v_cvt_pk_bf16_f32 v74, v80, v81
    v_cvt_pk_bf16_f32 v75, v82, v83
    ds_read_b32 v80, v109 offset:8
    ds_read_b128 v[76:79], v4 offset:1280
    v_add_f32_dpp v103, v101, v103 quad_perm:[2,2,2,2] row_mask:0xf bank_mask:0xf
    v_add_f32_dpp v102, v100, v102 quad_perm:[2,2,2,2] row_mask:0xf bank_mask:0xf
    v_add_f32_dpp v101, v99, v101 quad_perm:[2,2,2,2] row_mask:0xf bank_mask:0xf
    v_add_f32_dpp v100, v98, v100 quad_perm:[2,2,2,2] row_mask:0xf bank_mask:0xf
    v_add_f32_dpp v99, v97, v99 quad_perm:[2,2,2,2] row_mask:0xf bank_mask:0xf
    v_add_f32_dpp v98, v96, v98 quad_perm:[2,2,2,2] row_mask:0xf bank_mask:0xf
    v_add_f32_dpp v97, v95, v97 quad_perm:[2,2,2,2] row_mask:0xf bank_mask:0xf
    v_add_f32_dpp v96, v94, v96 quad_perm:[2,2,2,2] row_mask:0xf bank_mask:0xf
    v_add_f32_dpp v95, v93, v95 quad_perm:[2,2,2,2] row_mask:0xf bank_mask:0xf
    v_add_f32_dpp v94, v92, v94 quad_perm:[2,2,2,2] row_mask:0xf bank_mask:0xf
    v_add_f32_dpp v93, v91, v93 quad_perm:[2,2,2,2] row_mask:0xf bank_mask:0xf
    v_add_f32_dpp v92, v90, v92 quad_perm:[2,2,2,2] row_mask:0xf bank_mask:0xf
    v_add_f32_dpp v91, v89, v91 quad_perm:[2,2,2,2] row_mask:0xf bank_mask:0xf
    v_add_f32_dpp v90, v88, v90 quad_perm:[2,2,2,2] row_mask:0xf bank_mask:0xf
    v_cvt_pk_bf16_f32 v104, v92, v93
    v_cvt_pk_bf16_f32 v105, v94, v95
    v_cvt_pk_bf16_f32 v92, v96, v97
    v_cvt_pk_bf16_f32 v93, v98, v99
    v_cvt_pk_bf16_f32 v94, v100, v101
    v_cvt_pk_bf16_f32 v95, v102, v103
    ds_read_b128 v[96:99], v4 offset:1536
    s_waitcnt lgkmcnt(1)
    v_readfirstlane_b32 s10, v80
    s_nop 0
    s_cmp_eq_u32 s10, 0
    s_cbranch_scc1 Lcsl_42
Lcok_41:
    v_add_f32 v68, v68, v76
    v_add_f32 v69, v69, v77
    v_add_f32 v70, v70, v78
    v_cvt_pk_bf16_f32 v68, v68, v69
    v_cvt_pk_bf16_f32 v69, v70, v71
    v_cndmask_b32_dpp v70, v74, v84, vcc quad_perm:[0,0,0,0] row_mask:0xf bank_mask:0xf
    v_cndmask_b32_dpp v71, v75, v85, vcc quad_perm:[0,0,0,0] row_mask:0xf bank_mask:0xf
    v_cndmask_b32_dpp v68, v72, v68, vcc quad_perm:[0,0,0,0] row_mask:0xf bank_mask:0xf
    v_cndmask_b32_dpp v69, v73, v69, vcc quad_perm:[0,0,0,0] row_mask:0xf bank_mask:0xf
    s_waitcnt lgkmcnt(0)
    v_add_f32 v88, v88, v96
    v_add_f32 v89, v89, v97
    v_add_f32 v90, v90, v98
    v_cvt_pk_bf16_f32 v88, v88, v89
    v_cvt_pk_bf16_f32 v89, v90, v91
    v_cndmask_b32_dpp v90, v94, v104, vcc quad_perm:[0,0,0,0] row_mask:0xf bank_mask:0xf
    v_cndmask_b32_dpp v91, v95, v105, vcc quad_perm:[0,0,0,0] row_mask:0xf bank_mask:0xf
    v_cndmask_b32_dpp v88, v92, v88, vcc quad_perm:[0,0,0,0] row_mask:0xf bank_mask:0xf
    v_cndmask_b32_dpp v89, v93, v89, vcc quad_perm:[0,0,0,0] row_mask:0xf bank_mask:0xf
    s_mov_b64 exec, s[12:13]
    buffer_store_dwordx4 v[28:31], v5, s[64:67], s89 offen offset:512 sc1
    s_mov_b64 exec, -1
    s_mov_b64 exec, s[12:13]
    buffer_store_dwordx4 v[48:51], v5, s[64:67], s89 offen offset:1024 sc1
    s_mov_b64 exec, -1
    s_mov_b64 exec, s[12:13]
    buffer_store_dwordx4 v[68:71], v5, s[64:67], s89 offen offset:2560 sc1
    s_mov_b64 exec, -1
    s_mov_b64 exec, s[12:13]
    buffer_store_dwordx4 v[88:91], v5, s[64:67], s89 offen offset:3072 sc1
    s_mov_b64 exec, -1
L_g2c:
    v_mov_b32 v8, v242
    v_xor_b32 v9, 64, v242
    v_add_u32 v10, 65536, v8
    v_add_u32 v12, 131072, v8
    v_add_u32 v11, 65536, v9
    v_add_u32 v13, 131072, v9
    s_waitcnt vmcnt(4)
    s_barrier
    s_add_u32 s87, s84, s36
    buffer_load_dwordx4 v[112:115], v240, s[64:67], s87 offen offset:0 sc1
    buffer_load_dwordx4 v[116:119], v240, s[64:67], s87 offen offset:1024 sc1
    buffer_load_dwordx4 v[120:123], v240, s[64:67], s87 offen offset:2048 sc1
    ds_read_b64_tr_b16 v[20:21], v10 offset:0
    ds_read_b64_tr_b16 v[22:23], v10 offset:2048
    ds_read_b64_tr_b16 v[24:25], v11 offset:0
    ds_read_b64_tr_b16 v[26:27], v11 offset:2048
    ds_read_b64_tr_b16 v[28:29], v10 offset:1024
    ds_read_b64_tr_b16 v[30:31], v10 offset:3072
    ds_read_b64_tr_b16 v[32:33], v11 offset:1024
    ds_read_b64_tr_b16 v[34:35], v11 offset:3072
    s_lshl_b32 s10, s81, 7
    v_lshl_add_u32 v252, v1, 2, s10
    s_lshl_b32 s10, s80, 2
    s_add_u32 s10, s10, 4096
    v_mov_b32 v2, s10
    v_cmp_lt_u32 vcc, 31, v1
    s_mov_b32 s79, 12656640
    v_lshrrev_b32 v6, 3, v1
    v_cndmask_b32 v252, v252, v2, vcc
    v_lshlrev_b32 v6, 12, v6
    v_and_b32 v3, 7, v1
    v_lshl_add_u32 v6, v3, 4, v6
    s_lshl_b32 s6, s81, 3
    s_add_u32 s6, s6, s3
    s_lshl_b32 s6, s6, 15
    s_lshl_b32 s10, s80, 7
    s_add_u32 s6, s6, s10
    s_add_u32 s6, s6, 10485760
    v_and_b32 v4, 31, v1
    v_lshlrev_b32 v7, 2, v4
    v_lshrrev_b32 v15, 5, v1
    v_lshlrev_b32 v5, 4, v15
    v_lshl_add_u32 v14, v4, 10, v5
    v_bfe_u32 v4, v1, 2, 2
    v_lshl_add_u32 v15, v15, 3, v4
    v_lshlrev_b32 v15, 7, v15
    v_bfe_u32 v4, v1, 4, 1
    v_lshl_add_u32 v15, v4, 5, v15
    v_and_b32 v4, 3, v1
    v_lshl_add_u32 v15, v4, 3, v15
    s_lshr_b32 s10, s3, 1
    s_lshl_b32 s10, s10, 11
    s_and_b32 s11, s3, 1
    s_lshl_b32 s11, s11, 6
    s_add_u32 s10, s10, s11
    s_add_u32 s10, s10, 155648
    v_add_u32 v15, s10, v15
    s_lshl_b32 s10, s3, 10
    s_add_u32 s10, s10, 155648
    v_add_u32 v79, s10, v240
    s_xor_b32 s10, s83, 0
    s_mul_i32 s10, s10, 6144
    s_add_u32 s10, s10, 0
    v_add_u32 v78, s10, v240
    s_xor_b32 s10, s83, 2
    s_mul_i32 s10, s10, 6144
    s_add_u32 s10, s10, 0
    v_add_u32 v17, s10, v240
    s_xor_b32 s10, s83, 0
    s_mul_i32 s10, s10, 6144
    s_add_u32 s10, s10, 133120
    v_add_u32 v18, s10, v240
    s_xor_b32 s10, s83, 2
    s_mul_i32 s10, s10, 6144
    s_add_u32 s10, s10, 135168
    v_add_u32 v19, s10, v240
    s_add_u32 s87, s84, s36
    buffer_load_dwordx4 v[124:127], v240, s[64:67], s87 offen offset:3072 sc1
    s_add_u32 s87, s84, s37
    buffer_load_dwordx4 v[128:131], v240, s[64:67], s87 offen offset:0 sc1
    buffer_load_dwordx4 v[132:135], v240, s[64:67], s87 offen offset:1024 sc1
    s_waitcnt vmcnt(5) lgkmcnt(6)
    v_mfma_f32_32x32x16_bf16 v[44:59], v[20:23], v[112:115], 0
    ds_read_b64_tr_b16 v[36:37], v10 offset:4096
    ds_read_b64_tr_b16 v[38:39], v10 offset:6144
    s_add_u32 s87, s84, s37
    buffer_load_dwordx4 v[136:139], v240, s[64:67], s87 offen offset:2048 sc1
    s_waitcnt lgkmcnt(6)
    v_mfma_f32_32x32x16_bf16 v[60:75], v[24:27], v[112:115], 0
    ds_read_b64_tr_b16 v[40:41], v11 offset:4096
    ds_read_b64_tr_b16 v[42:43], v11 offset:6144
    s_waitcnt vmcnt(5) lgkmcnt(6)
    v_mfma_f32_32x32x16_bf16 v[44:59], v[28:31], v[116:119], v[44:59]
    ds_read_b64_tr_b16 v[20:21], v10 offset:5120
    ds_read_b64_tr_b16 v[22:23], v10 offset:7168
    s_add_u32 s87, s84, s37
    buffer_load_dwordx4 v[140:143], v240, s[64:67], s87 offen offset:3072 sc1
    s_waitcnt lgkmcnt(6)
    v_mfma_f32_32x32x16_bf16 v[60:75], v[32:35], v[116:119], v[60:75]
    ds_read_b64_tr_b16 v[24:25], v11 offset:5120
    ds_read_b64_tr_b16 v[26:27], v11 offset:7168
    s_barrier
    s_cmp_lg_u32 s3, 4
    s_cbranch_scc1 Low_50
    s_lshl_b32 s10, s2, 2
    s_add_u32 s10, s10, 12656640
    v_mov_b32 v250, 0
    v_mov_b32 v251, s76
    s_mov_b64 exec, 1
    buffer_store_dword v251, v250, s[64:67], s10 offen sc1
    s_mov_b64 exec, -1
Low_50:
    s_waitcnt vmcnt(5) lgkmcnt(6)
    v_mfma_f32_32x32x16_bf16 v[44:59], v[36:39], v[120:123], v[44:59]
    ds_read_b64_tr_b16 v[28:29], v10 offset:32768
    ds_read_b64_tr_b16 v[30:31], v10 offset:34816
    s_add_u32 s87, s84, s38
    buffer_load_dwordx4 v[144:147], v240, s[64:67], s87 offen offset:0 sc1
    s_waitcnt lgkmcnt(6)
    v_mfma_f32_32x32x16_bf16 v[60:75], v[40:43], v[120:123], v[60:75]
    ds_read_b64_tr_b16 v[32:33], v11 offset:32768
    ds_read_b64_tr_b16 v[34:35], v11 offset:34816
    s_waitcnt vmcnt(5) lgkmcnt(6)
    v_mfma_f32_32x32x16_bf16 v[44:59], v[20:23], v[124:127], v[44:59]
    ds_read_b64_tr_b16 v[36:37], v10 offset:33792
    ds_read_b64_tr_b16 v[38:39], v10 offset:35840
    s_add_u32 s87, s84, s38
    buffer_load_dwordx4 v[148:151], v240, s[64:67], s87 offen offset:1024 sc1
    s_waitcnt lgkmcnt(6)
    v_mfma_f32_32x32x16_bf16 v[60:75], v[24:27], v[124:127], v[60:75]
    ds_read_b64_tr_b16 v[40:41], v11 offset:33792
    ds_read_b64_tr_b16 v[42:43], v11 offset:35840
    s_waitcnt vmcnt(5) lgkmcnt(6)
    v_mfma_f32_32x32x16_bf16 v[44:59], v[28:31], v[128:131], v[44:59]
    ds_read_b64_tr_b16 v[20:21], v10 offset:36864
    ds_read_b64_tr_b16 v[22:23], v10 offset:38912
    s_add_u32 s87, s84, s38
    buffer_load_dwordx4 v[152:155], v240, s[64:67], s87 offen offset:2048 sc1
    s_waitcnt lgkmcnt(6)
    v_mfma_f32_32x32x16_bf16 v[60:75], v[32:35], v[128:131], v[60:75]
    ds_read_b64_tr_b16 v[24:25], v11 offset:36864
    ds_read_b64_tr_b16 v[26:27], v11 offset:38912
    s_waitcnt vmcnt(5) lgkmcnt(6)
    v_mfma_f32_32x32x16_bf16 v[44:59], v[36:39], v[132:135], v[44:59]
    ds_read_b64_tr_b16 v[28:29], v10 offset:37888
    ds_read_b64_tr_b16 v[30:31], v10 offset:39936
    s_add_u32 s87, s84, s38
    buffer_load_dwordx4 v[156:159], v240, s[64:67], s87 offen offset:3072 sc1
    s_waitcnt lgkmcnt(6)
    v_mfma_f32_32x32x16_bf16 v[60:75], v[40:43], v[132:135], v[60:75]
    ds_read_b64_tr_b16 v[32:33], v11 offset:37888
    ds_read_b64_tr_b16 v[34:35], v11 offset:39936
    s_waitcnt vmcnt(5) lgkmcnt(6)
    v_mfma_f32_32x32x16_bf16 v[44:59], v[20:23], v[136:139], v[44:59]
    ds_read_b64_tr_b16 v[36:37], v12 offset:0
    ds_read_b64_tr_b16 v[38:39], v12 offset:2048
    s_add_u32 s87, s84, s39
    buffer_load_dwordx4 v[160:163], v240, s[64:67], s87 offen offset:0 sc1
    s_waitcnt lgkmcnt(6)
    v_mfma_f32_32x32x16_bf16 v[60:75], v[24:27], v[136:139], v[60:75]
    ds_read_b64_tr_b16 v[40:41], v13 offset:0
    ds_read_b64_tr_b16 v[42:43], v13 offset:2048
    s_waitcnt vmcnt(5) lgkmcnt(6)
    v_mfma_f32_32x32x16_bf16 v[44:59], v[28:31], v[140:143], v[44:59]
    ds_read_b64_tr_b16 v[20:21], v12 offset:1024
    ds_read_b64_tr_b16 v[22:23], v12 offset:3072
    s_add_u32 s87, s84, s39
    buffer_load_dwordx4 v[164:167], v240, s[64:67], s87 offen offset:1024 sc1
    s_waitcnt lgkmcnt(6)
    v_mfma_f32_32x32x16_bf16 v[60:75], v[32:35], v[140:143], v[60:75]
    ds_read_b64_tr_b16 v[24:25], v13 offset:1024
    ds_read_b64_tr_b16 v[26:27], v13 offset:3072
    s_waitcnt vmcnt(5) lgkmcnt(6)
    v_mfma_f32_32x32x16_bf16 v[44:59], v[36:39], v[144:147], v[44:59]
    ds_read_b64_tr_b16 v[28:29], v12 offset:4096
    ds_read_b64_tr_b16 v[30:31], v12 offset:6144
    s_add_u32 s87, s84, s39
    buffer_load_dwordx4 v[168:171], v240, s[64:67], s87 offen offset:2048 sc1
    s_waitcnt lgkmcnt(6)
    v_mfma_f32_32x32x16_bf16 v[60:75], v[40:43], v[144:147], v[60:75]
    ds_read_b64_tr_b16 v[32:33], v13 offset:4096
    ds_read_b64_tr_b16 v[34:35], v13 offset:6144
    s_waitcnt vmcnt(5) lgkmcnt(6)
    v_mfma_f32_32x32x16_bf16 v[44:59], v[20:23], v[148:151], v[44:59]
    ds_read_b64_tr_b16 v[36:37], v12 offset:5120
    ds_read_b64_tr_b16 v[38:39], v12 offset:7168
    s_add_u32 s87, s84, s39
    buffer_load_dwordx4 v[172:175], v240, s[64:67], s87 offen offset:3072 sc1
    s_waitcnt lgkmcnt(6)
    v_mfma_f32_32x32x16_bf16 v[60:75], v[24:27], v[148:151], v[60:75]
    ds_read_b64_tr_b16 v[40:41], v13 offset:5120
    ds_read_b64_tr_b16 v[42:43], v13 offset:7168
    s_barrier
    s_waitcnt vmcnt(5) lgkmcnt(6)
    v_mfma_f32_32x32x16_bf16 v[44:59], v[28:31], v[152:155], v[44:59]
    ds_read_b64_tr_b16 v[20:21], v8 offset:0
    ds_read_b64_tr_b16 v[22:23], v8 offset:2048
    s_add_u32 s87, s84, s40
    buffer_load_dwordx4 v[112:115], v240, s[64:67], s87 offen offset:0 sc1
    s_waitcnt lgkmcnt(6)
    v_mfma_f32_32x32x16_bf16 v[60:75], v[32:35], v[152:155], v[60:75]
    ds_read_b64_tr_b16 v[24:25], v9 offset:0
    ds_read_b64_tr_b16 v[26:27], v9 offset:2048
    s_add_u32 m0, s91, 98304
    s_lshl_b32 s13, s42, 4
    s_add_u32 s13, s13, s90
    buffer_load_dwordx4 v241, s[68:71], s13 offen lds
    s_waitcnt vmcnt(6) lgkmcnt(6)
    v_mfma_f32_32x32x16_bf16 v[44:59], v[36:39], v[156:159], v[44:59]
    ds_read_b64_tr_b16 v[28:29], v8 offset:1024
    ds_read_b64_tr_b16 v[30:31], v8 offset:3072
    s_add_u32 s87, s84, s40
    buffer_load_dwordx4 v[116:119], v240, s[64:67], s87 offen offset:1024 sc1
    s_waitcnt lgkmcnt(6)
    v_mfma_f32_32x32x16_bf16 v[60:75], v[40:43], v[156:159], v[60:75]
    ds_read_b64_tr_b16 v[32:33], v9 offset:1024
    ds_read_b64_tr_b16 v[34:35], v9 offset:3072
    s_add_u32 m0, s91, 99328
    s_add_u32 s13, s13, 8192
    buffer_load_dwordx4 v241, s[68:71], s13 offen lds
    s_waitcnt vmcnt(7) lgkmcnt(6)
    v_mfma_f32_32x32x16_bf16 v[44:59], v[20:23], v[160:163], v[44:59]
    ds_read_b64_tr_b16 v[36:37], v8 offset:4096
    ds_read_b64_tr_b16 v[38:39], v8 offset:6144
    s_add_u32 s87, s84, s40
    buffer_load_dwordx4 v[120:123], v240, s[64:67], s87 offen offset:2048 sc1
    s_waitcnt lgkmcnt(6)
    v_mfma_f32_32x32x16_bf16 v[60:75], v[24:27], v[160:163], v[60:75]
    ds_read_b64_tr_b16 v[40:41], v9 offset:4096
    ds_read_b64_tr_b16 v[42:43], v9 offset:6144
    s_add_u32 m0, s91, 100352
    s_add_u32 s13, s13, 8192
    buffer_load_dwordx4 v241, s[68:71], s13 offen lds
    s_waitcnt vmcnt(8) lgkmcnt(6)
    v_mfma_f32_32x32x16_bf16 v[44:59], v[28:31], v[164:167], v[44:59]
    ds_read_b64_tr_b16 v[20:21], v8 offset:5120
    ds_read_b64_tr_b16 v[22:23], v8 offset:7168
    s_add_u32 s87, s84, s40
    buffer_load_dwordx4 v[124:127], v240, s[64:67], s87 offen offset:3072 sc1
    s_waitcnt lgkmcnt(6)
    v_mfma_f32_32x32x16_bf16 v[60:75], v[32:35], v[164:167], v[60:75]
    ds_read_b64_tr_b16 v[24:25], v9 offset:5120
    ds_read_b64_tr_b16 v[26:27], v9 offset:7168
    s_add_u32 m0, s91, 101376
    s_add_u32 s13, s13, 8192
    buffer_load_dwordx4 v241, s[68:71], s13 offen lds
    s_waitcnt vmcnt(9) lgkmcnt(6)
    v_mfma_f32_32x32x16_bf16 v[44:59], v[36:39], v[168:171], v[44:59]
    ds_read_b64_tr_b16 v[28:29], v8 offset:32768
    ds_read_b64_tr_b16 v[30:31], v8 offset:34816
    s_add_u32 s87, s84, s41
    buffer_load_dwordx4 v[128:131], v240, s[64:67], s87 offen offset:0 sc1
    s_waitcnt lgkmcnt(6)
    v_mfma_f32_32x32x16_bf16 v[60:75], v[40:43], v[168:171], v[60:75]
    ds_read_b64_tr_b16 v[32:33], v9 offset:32768
    ds_read_b64_tr_b16 v[34:35], v9 offset:34816
    s_add_u32 m0, s91, 102400
    s_add_u32 s13, s13, 8192
    buffer_load_dwordx4 v241, s[68:71], s13 offen lds
    s_waitcnt vmcnt(10) lgkmcnt(6)
    v_mfma_f32_32x32x16_bf16 v[44:59], v[20:23], v[172:175], v[44:59]
    ds_read_b64_tr_b16 v[36:37], v8 offset:33792
    ds_read_b64_tr_b16 v[38:39], v8 offset:35840
    s_add_u32 s87, s84, s41
    buffer_load_dwordx4 v[132:135], v240, s[64:67], s87 offen offset:1024 sc1
    s_waitcnt lgkmcnt(6)
    v_mfma_f32_32x32x16_bf16 v[60:75], v[24:27], v[172:175], v[60:75]
    ds_read_b64_tr_b16 v[40:41], v9 offset:33792
    ds_read_b64_tr_b16 v[42:43], v9 offset:35840
    buffer_load_dword v249, v252, s[64:67], s79 offen sc1
    s_add_u32 m0, s91, 103424
    s_add_u32 s13, s13, 8192
    buffer_load_dwordx4 v241, s[68:71], s13 offen lds
    s_waitcnt vmcnt(12) lgkmcnt(6)
    v_mfma_f32_32x32x16_bf16 v[44:59], v[28:31], v[112:115], v[44:59]
    ds_read_b64_tr_b16 v[20:21], v8 offset:36864
    ds_read_b64_tr_b16 v[22:23], v8 offset:38912
    s_add_u32 s87, s84, s41
    buffer_load_dwordx4 v[136:139], v240, s[64:67], s87 offen offset:2048 sc1
    s_waitcnt lgkmcnt(6)
    v_mfma_f32_32x32x16_bf16 v[60:75], v[32:35], v[112:115], v[60:75]
    ds_read_b64_tr_b16 v[24:25], v9 offset:36864
    ds_read_b64_tr_b16 v[26:27], v9 offset:38912
    s_add_u32 m0, s91, 104448
    s_add_u32 s13, s13, 8192
    buffer_load_dwordx4 v241, s[68:71], s13 offen lds
    s_waitcnt vmcnt(12) lgkmcnt(6)
    v_mfma_f32_32x32x16_bf16 v[44:59], v[36:39], v[116:119], v[44:59]
    ds_read_b64_tr_b16 v[28:29], v8 offset:37888
    ds_read_b64_tr_b16 v[30:31], v8 offset:39936
    s_add_u32 s87, s84, s41
    buffer_load_dwordx4 v[140:143], v240, s[64:67], s87 offen offset:3072 sc1
    s_waitcnt lgkmcnt(6)
    v_mfma_f32_32x32x16_bf16 v[60:75], v[40:43], v[116:119], v[60:75]
    ds_read_b64_tr_b16 v[32:33], v9 offset:37888
    ds_read_b64_tr_b16 v[34:35], v9 offset:39936
    s_add_u32 m0, s91, 105472
    s_add_u32 s13, s13, 8192
    buffer_load_dwordx4 v241, s[68:71], s13 offen lds
    s_barrier
    s_waitcnt vmcnt(12) lgkmcnt(6)
    v_mfma_f32_32x32x16_bf16 v[44:59], v[20:23], v[120:123], v[44:59]
    ds_read_b64_tr_b16 v[36:37], v10 offset:0
    ds_read_b64_tr_b16 v[38:39], v10 offset:2048
    s_add_u32 s87, s84, s42
    buffer_load_dwordx4 v[144:147], v240, s[64:67], s87 offen offset:0 sc1
    s_waitcnt lgkmcnt(6)
    v_mfma_f32_32x32x16_bf16 v[60:75], v[24:27], v[120:123], v[60:75]
    ds_read_b64_tr_b16 v[40:41], v11 offset:0
    ds_read_b64_tr_b16 v[42:43], v11 offset:2048
    s_waitcnt vmcnt(11) lgkmcnt(6)
    v_mfma_f32_32x32x16_bf16 v[44:59], v[28:31], v[124:127], v[44:59]
    ds_read_b64_tr_b16 v[20:21], v10 offset:1024
    ds_read_b64_tr_b16 v[22:23], v10 offset:3072
    s_add_u32 s87, s84, s42
    buffer_load_dwordx4 v[148:151], v240, s[64:67], s87 offen offset:1024 sc1
    v_lshlrev_b32 v188, 16, v244
    v_and_b32 v189, 0xffff0000, v244
    v_lshlrev_b32 v190, 16, v245
    v_and_b32 v191, 0xffff0000, v245
    s_waitcnt lgkmcnt(6)
    v_mfma_f32_32x32x16_bf16 v[60:75], v[32:35], v[124:127], v[60:75]
    ds_read_b64_tr_b16 v[24:25], v11 offset:1024
    ds_read_b64_tr_b16 v[26:27], v11 offset:3072
    v_lshlrev_b32 v192, 16, v246
    v_and_b32 v193, 0xffff0000, v246
    v_lshlrev_b32 v194, 16, v247
    v_and_b32 v195, 0xffff0000, v247
    s_waitcnt vmcnt(10) lgkmcnt(6)
    v_mfma_f32_32x32x16_bf16 v[44:59], v[36:39], v[128:131], v[44:59]
    ds_read_b64_tr_b16 v[28:29], v10 offset:4096
    ds_read_b64_tr_b16 v[30:31], v10 offset:6144
    s_add_u32 s87, s84, s42
    buffer_load_dwordx4 v[152:155], v240, s[64:67], s87 offen offset:2048 sc1
    s_waitcnt lgkmcnt(6)
    v_mfma_f32_32x32x16_bf16 v[60:75], v[40:43], v[128:131], v[60:75]
    ds_read_b64_tr_b16 v[32:33], v11 offset:4096
    ds_read_b64_tr_b16 v[34:35], v11 offset:6144
    s_waitcnt vmcnt(9) lgkmcnt(6)
    v_mfma_f32_32x32x16_bf16 v[44:59], v[20:23], v[132:135], v[44:59]
    ds_read_b64_tr_b16 v[36:37], v10 offset:5120
    ds_read_b64_tr_b16 v[38:39], v10 offset:7168
    s_add_u32 s87, s84, s42
    buffer_load_dwordx4 v[156:159], v240, s[64:67], s87 offen offset:3072 sc1
    s_waitcnt lgkmcnt(6)
    v_mfma_f32_32x32x16_bf16 v[60:75], v[24:27], v[132:135], v[60:75]
    ds_read_b64_tr_b16 v[40:41], v11 offset:5120
    ds_read_b64_tr_b16 v[42:43], v11 offset:7168
    s_waitcnt vmcnt(4)
    s_barrier
    s_waitcnt vmcnt(7) lgkmcnt(6)
    v_mfma_f32_32x32x16_bf16 v[44:59], v[28:31], v[136:139], v[44:59]
    ds_read_b64_tr_b16 v[20:21], v10 offset:32768
    ds_read_b64_tr_b16 v[22:23], v10 offset:34816
    s_waitcnt vmcnt(9)
Lpok_51r:
    v_cmp_ne_u32 vcc, s76, v249
    s_nop 0
    s_cmp_lg_u64 vcc, 0
    s_cbranch_scc1 Lplp_52
Lpok_51:
    buffer_load_dwordx4 v[180:183], v6, s[64:67], s6 offen sc1
    buffer_load_dword v16, v7, s[64:67], s51 offen sc1
    s_waitcnt lgkmcnt(6)
    v_mfma_f32_32x32x16_bf16 v[60:75], v[32:35], v[136:139], v[60:75]
    ds_read_b64_tr_b16 v[24:25], v11 offset:32768
    ds_read_b64_tr_b16 v[26:27], v11 offset:34816
    s_waitcnt vmcnt(7) lgkmcnt(6)
    v_mfma_f32_32x32x16_bf16 v[44:59], v[36:39], v[140:143], v[44:59]
    ds_read_b64_tr_b16 v[28:29], v10 offset:33792
    ds_read_b64_tr_b16 v[30:31], v10 offset:35840
    s_waitcnt lgkmcnt(6)
    v_mfma_f32_32x32x16_bf16 v[60:75], v[40:43], v[140:143], v[60:75]
    ds_read_b64_tr_b16 v[32:33], v11 offset:33792
    ds_read_b64_tr_b16 v[34:35], v11 offset:35840
    s_waitcnt vmcnt(5) lgkmcnt(6)
    v_mfma_f32_32x32x16_bf16 v[44:59], v[20:23], v[144:147], v[44:59]
    ds_read_b64_tr_b16 v[36:37], v10 offset:36864
    ds_read_b64_tr_b16 v[38:39], v10 offset:38912
    s_waitcnt lgkmcnt(6)
    v_mfma_f32_32x32x16_bf16 v[60:75], v[24:27], v[144:147], v[60:75]
    ds_read_b64_tr_b16 v[40:41], v11 offset:36864
    ds_read_b64_tr_b16 v[42:43], v11 offset:38912
    s_waitcnt vmcnt(4) lgkmcnt(6)
    v_mfma_f32_32x32x16_bf16 v[44:59], v[28:31], v[148:151], v[44:59]
    ds_read_b64_tr_b16 v[20:21], v10 offset:37888
    ds_read_b64_tr_b16 v[22:23], v10 offset:39936
    s_waitcnt lgkmcnt(6)
    v_mfma_f32_32x32x16_bf16 v[60:75], v[32:35], v[148:151], v[60:75]
    ds_read_b64_tr_b16 v[24:25], v11 offset:37888
    ds_read_b64_tr_b16 v[26:27], v11 offset:39936
    s_waitcnt vmcnt(3) lgkmcnt(6)
    v_mfma_f32_32x32x16_bf16 v[44:59], v[36:39], v[152:155], v[44:59]
    s_waitcnt lgkmcnt(4)
    v_mfma_f32_32x32x16_bf16 v[60:75], v[40:43], v[152:155], v[60:75]
    s_waitcnt vmcnt(2) lgkmcnt(2)
    v_mfma_f32_32x32x16_bf16 v[44:59], v[20:23], v[156:159], v[44:59]
    s_waitcnt lgkmcnt(0)
    v_mfma_f32_32x32x16_bf16 v[60:75], v[24:27], v[156:159], v[60:75]
    s_waitcnt vmcnt(0)
    ds_write_b128 v79, v[180:183]
    s_nop 7
    ds_write_b128 v78, v[52:55] offset:0
    ds_write_b128 v78, v[56:59] offset:1024
    ds_write_b128 v78, v[60:63] offset:2048
    ds_write_b128 v78, v[64:67] offset:3072
    ds_write_b128 v78, v[68:71] offset:4096
    ds_write_b128 v78, v[72:75] offset:5120
    v_sub_f32 v188, v188, v44
    v_fmac_f32 v44, v16, v188
    v_sub_f32 v189, v189, v45
    v_fmac_f32 v45, v16, v189
    v_sub_f32 v190, v190, v46
    v_fmac_f32 v46, v16, v190
    v_sub_f32 v191, v191, v47
    v_fmac_f32 v47, v16, v191
    v_sub_f32 v192, v192, v48
    v_fmac_f32 v48, v16, v192
    v_sub_f32 v193, v193, v49
    v_fmac_f32 v49, v16, v193
    v_sub_f32 v194, v194, v50
    v_fmac_f32 v50, v16, v194
    v_sub_f32 v195, v195, v51
    v_fmac_f32 v51, v16, v195
    v_sub_f32 v3, 1.0, v16
    s_waitcnt lgkmcnt(0)
    s_barrier
    ds_read_b64_tr_b16 v[176:177], v15 offset:0
    ds_read_b64_tr_b16 v[178:179], v15 offset:512
    ds_read_b128 v[52:55], v17 offset:0
    ds_read_b128 v[56:59], v17 offset:1024
    ds_read_b128 v[60:63], v18 offset:0
    ds_read_b128 v[64:67], v18 offset:1024
    ds_read_b128 v[68:71], v19 offset:0
    ds_read_b128 v[72:75], v19 offset:1024
    s_waitcnt lgkmcnt(6)
    v_lshlrev_b32 v4, 16, v176
    v_and_b32 v5, 0xffff0000, v176
    v_fmac_f32 v44, v16, v4
    v_fmac_f32 v45, v16, v5
    v_lshlrev_b32 v4, 16, v177
    v_and_b32 v5, 0xffff0000, v177
    v_fmac_f32 v46, v16, v4
    v_fmac_f32 v47, v16, v5
    v_lshlrev_b32 v4, 16, v178
    v_and_b32 v5, 0xffff0000, v178
    v_fmac_f32 v48, v16, v4
    v_fmac_f32 v49, v16, v5
    v_lshlrev_b32 v4, 16, v179
    v_and_b32 v5, 0xffff0000, v179
    v_fmac_f32 v50, v16, v4
    v_fmac_f32 v51, v16, v5
    s_waitcnt lgkmcnt(4)
    v_fmac_f32 v44, v3, v52
    v_fmac_f32 v45, v3, v53
    v_fmac_f32 v46, v3, v54
    v_fmac_f32 v47, v3, v55
    v_fmac_f32 v48, v3, v56
    v_fmac_f32 v49, v3, v57
    v_fmac_f32 v50, v3, v58
    v_fmac_f32 v51, v3, v59
    s_waitcnt lgkmcnt(2)
    v_fmac_f32 v44, v3, v60
    v_fmac_f32 v45, v3, v61
    v_fmac_f32 v46, v3, v62
    v_fmac_f32 v47, v3, v63
    v_fmac_f32 v48, v3, v64
    v_fmac_f32 v49, v3, v65
    v_fmac_f32 v50, v3, v66
    v_fmac_f32 v51, v3, v67
    s_waitcnt lgkmcnt(0)
    v_fmac_f32 v44, v3, v68
    v_fmac_f32 v45, v3, v69
    v_fmac_f32 v46, v3, v70
    v_fmac_f32 v47, v3, v71
    v_fmac_f32 v48, v3, v72
    v_fmac_f32 v49, v3, v73
    v_fmac_f32 v50, v3, v74
    v_fmac_f32 v51, v3, v75
    v_cvt_pk_bf16_f32 v188, v44, v45
    v_cvt_pk_bf16_f32 v189, v46, v47
    v_cvt_pk_bf16_f32 v190, v48, v49
    v_cvt_pk_bf16_f32 v191, v50, v51
    buffer_store_dwordx4 v[188:191], v14, s[72:75], s85 offen
    s_endpgm
L_aux:
    s_mov_b32 s78, 0
    v_mov_b32 v235, 0
    v_mov_b32 v252, 0
    s_mov_b32 s66, 0xe00000
    s_mov_b32 s67, 0x20000
    s_mov_b32 s70, 0x1c0000
    s_mov_b32 s71, 0x20000
    s_mov_b32 s74, 0x200000
    s_mov_b32 s75, 0x20000
    s_mov_b32 s64, s48
    s_and_b32 s65, s49, 0xffff
    s_mov_b32 s68, s40
    s_and_b32 s69, s41, 0xffff
    s_mov_b32 s72, s44
    s_and_b32 s73, s45, 0xffff
    s_lshl_b32 s6, s4, 2
    s_add_u32 s6, s6, s5
    v_lshlrev_b32 v20, 4, v1
    s_mov_b32 s9, 12664832
    buffer_load_dword v12, v235, s[64:67], s9 offen sc1
    s_lshl_b32 s7, s6, 16
    s_lshl_b32 s8, s3, 13
    s_add_u32 s7, s7, s8
    s_mul_i32 s8, s3, 8320
    s_cmp_ge_u32 s3, 2
    s_cselect_b32 s10, 81664, 0
    s_add_u32 s8, s8, s10
    s_cmp_lg_u32 s3, 4
    s_cbranch_scc1 Low_3
    global_load_dwordx4 v[28:31], v20, s[42:43]
Low_3:
    s_cmp_ge_u32 s3, 4
    s_cbranch_scc0 Lr1_4
    s_and_b32 s11, s3, 3
    s_lshl_b32 s24, s6, 16
    s_lshl_b32 s12, s11, 12
    s_add_u32 s24, s24, s12
    s_mul_i32 s12, s11, 4160
    s_add_u32 m0, s12, 0
    s_add_u32 s13, s24, 0
    buffer_load_dwordx4 v20, s[52:55], s13 offen lds
    s_add_u32 m0, s12, 1040
    s_add_u32 s13, s24, 1024
    buffer_load_dwordx4 v20, s[52:55], s13 offen lds
    s_add_u32 m0, s12, 2080
    s_add_u32 s13, s24, 2048
    buffer_load_dwordx4 v20, s[52:55], s13 offen lds
    s_add_u32 m0, s12, 3120
    s_add_u32 s13, s24, 3072
    buffer_load_dwordx4 v20, s[52:55], s13 offen lds
    s_add_u32 m0, s12, 98304
    s_add_u32 s13, s24, 16384
    buffer_load_dwordx4 v20, s[52:55], s13 offen lds
    s_add_u32 m0, s12, 99344
    s_add_u32 s13, s24, 17408
    buffer_load_dwordx4 v20, s[52:55], s13 offen lds
    s_add_u32 m0, s12, 100384
    s_add_u32 s13, s24, 18432
    buffer_load_dwordx4 v20, s[52:55], s13 offen lds
    s_add_u32 m0, s12, 101424
    s_add_u32 s13, s24, 19456
    buffer_load_dwordx4 v20, s[52:55], s13 offen lds
    s_add_u32 m0, s12, 114944
    s_add_u32 s13, s24, 32768
    buffer_load_dwordx4 v20, s[52:55], s13 offen lds
    s_add_u32 m0, s12, 115984
    s_add_u32 s13, s24, 33792
    buffer_load_dwordx4 v20, s[52:55], s13 offen lds
    s_add_u32 m0, s12, 117024
    s_add_u32 s13, s24, 34816
    buffer_load_dwordx4 v20, s[52:55], s13 offen lds
    s_add_u32 m0, s12, 118064
    s_add_u32 s13, s24, 35840
    buffer_load_dwordx4 v20, s[52:55], s13 offen lds
    s_add_u32 m0, s12, 131584
    s_add_u32 s13, s24, 49152
    buffer_load_dwordx4 v20, s[52:55], s13 offen lds
    s_add_u32 m0, s12, 132624
    s_add_u32 s13, s24, 50176
    buffer_load_dwordx4 v20, s[52:55], s13 offen lds
    s_add_u32 m0, s12, 133664
    s_add_u32 s13, s24, 51200
    buffer_load_dwordx4 v20, s[52:55], s13 offen lds
    s_add_u32 m0, s12, 134704
    s_add_u32 s13, s24, 52224
    buffer_load_dwordx4 v20, s[52:55], s13 offen lds
Lr1_4:
    s_lshr_b32 s10, s3, 1
    s_mul_i32 s10, s10, 16368
    s_and_b32 s11, s3, 1
    s_lshl_b32 s11, s11, 8
    s_add_u32 s88, s10, s11
    s_and_b32 s10, s3, 3
    s_mul_i32 s10, s10, 16368
    s_add_u32 s10, s10, 32768
    v_bfe_u32 v15, v1, 4, 1
    v_lshlrev_b32 v15, 8, v15
    v_lshrrev_b32 v16, 5, v1
    v_lshl_add_u32 v15, v16, 7, v15
    v_and_b32 v14, 15, v1
    v_mul_u32_u24 v16, 528, v14
    v_add3_u32 v153, v16, v15, s10
    s_bitcmp1_b32 s3, 2
    s_mov_b32 s11, 0x42006420
    s_cmov_b32 s11, 0x55315531
    s_mov_b32 s12, 0xeca88644
    s_cmov_b32 s12, 0xdb97db97
    s_mov_b32 s13, 0xff0
    s_cmov_b32 s13, 0xf0f0
    v_cmp_lt_u32 vcc, 7, v14
    v_mov_b32 v152, s11
    v_mov_b32 v16, s12
    v_cndmask_b32 v152, v152, v16, vcc
    v_and_b32 v16, 7, v1
    v_lshlrev_b32 v16, 2, v16
    v_bfe_u32 v152, v152, v16, 4
    v_bfe_u32 v16, s13, v14, 1
    v_mad_u32_u24 v152, v16, 31, v152
    v_mul_u32_u24 v152, 528, v152
    s_bfe_u32 s10, s3, 0x10001
    s_mul_i32 s11, s10, 32736
    s_add_u32 s11, s11, 41216
    v_add3_u32 v152, v152, v15, s11
    s_mul_i32 s10, s10, 4160
    s_and_b32 s11, s3, 1
    s_lshl_b32 s11, s11, 8
    s_add_u32 s10, s10, s11
    s_add_u32 s10, s10, 49216
    s_bitcmp1_b32 s3, 2
    s_mov_b32 s11, 0x1414000
    s_cmov_b32 s11, 0xc0804000
    s_cselect_b32 s12, 1024, 0
    s_add_u32 s10, s10, s12
    v_lshrrev_b32 v15, 4, v1
    v_lshlrev_b32 v15, 3, v15
    v_bfe_u32 v15, s11, v15, 8
    v_lshlrev_b32 v14, 4, v14
    v_lshl_add_u32 v14, v15, 3, v14
    v_add_u32 v154, s10, v14
    v_lshrrev_b32 v22, 4, v1
    v_bfe_u32 v23, v1, 2, 2
    v_lshl_add_u32 v23, v23, 2, v22
    v_mul_u32_u24 v23, 1040, v23
    v_and_b32 v8, 3, v1
    v_lshl_add_u32 v23, v8, 3, v23
    v_bfe_u32 v8, v1, 1, 3
    v_lshlrev_b32 v8, 13, v8
    v_lshl_add_u32 v8, v22, 5, v8
    v_and_b32 v9, 1, v1
    v_lshl_add_u32 v8, v9, 4, v8
    s_lshl_b32 s25, s6, 8
    s_add_u32 s25, s25, 8388608
    s_cmp_ge_u32 s3, 4
    s_cbranch_scc1 L_auxhi
    s_waitcnt vmcnt(0)
    s_or_b32 s10, s2, s3
    s_cmp_lg_u32 s10, 0
    s_cbranch_scc1 L_auxk
    s_mov_b32 s10, 0x9e3779b1
    v_mul_lo_u32 v12, v12, s10
    v_add_u32 v12, 0x7f4a7c15, v12
    v_mov_b32 v13, 1
    s_mov_b64 exec, 1
    global_store_dwordx2 v235, v[12:13], s[46:47] sc1
    buffer_store_dword v12, v235, s[64:67], s9 offen sc1
    s_mov_b64 exec, -1
    s_branch L_auxk
L_auxhi:
    s_waitcnt vmcnt(8)
    s_barrier
L_auxk:
    v_mul_f32 v167, 0x3fb8aa3b, v166
    v_mov_b32 v169, 0x3fb8aa3b
    v_fma_f32 v168, v166, v169, -v167
    v_fmac_f32 v168, 0x32a57060, v166
    v_exp_f32 v167, v167
    v_mul_f32 v168, 0x3f317218, v168
    v_fmac_f32 v167, v167, v168
    v_cvt_pk_bf16_f32 v167, v167, v167
    v_and_b32 v167, 0xffff0000, v167
    v_mul_f32 v160, v167, v160
    v_mul_f32 v161, v167, v161
    v_mul_f32 v162, v167, v162
    v_mul_f32 v163, v167, v163
    v_mul_f32 v160, 0x3fb8aa3b, v160
    v_mul_f32 v161, 0.15915494, v161
    v_mul_f32 v169, 0x43000000, v160
    v_exp_f32 v167, v160
    v_mul_f32 v166, 0x43000000, v161
    v_fract_f32 v168, v161
    v_exp_f32 v169, v169
    v_cos_f32 v172, v168
    v_fract_f32 v166, v166
    v_sin_f32 v173, v168
    v_cos_f32 v180, v166
    v_mul_f32 v172, v167, v172
    v_sin_f32 v181, v166
    v_mul_f32 v173, v167, v173
    v_mul_f32 v180, v169, v180
    v_pk_mul_f32 v[170:171], v[164:165], v[162:163] op_sel_hi:[1,0]
    v_mul_f32 v181, v169, v181
    v_pk_fma_f32 v[170:171], v[164:165], v[162:163], v[170:171] op_sel:[1,1,0] op_sel_hi:[0,1,1] neg_lo:[1,0,0]
    v_pk_mul_f32 v[174:175], v[172:173], v[172:173] op_sel_hi:[1,0]
    v_pk_mul_f32 v[182:183], v[180:181], v[180:181] op_sel_hi:[1,0]
    v_pk_fma_f32 v[174:175], v[172:173], v[172:173], v[174:175] op_sel:[1,1,0] op_sel_hi:[0,1,1] neg_lo:[1,0,0]
    v_pk_fma_f32 v[182:183], v[180:181], v[180:181], v[182:183] op_sel:[1,1,0] op_sel_hi:[0,1,1] neg_lo:[1,0,0]
    v_pk_mul_f32 v[176:177], v[174:175], v[174:175] op_sel_hi:[1,0]
    v_pk_mul_f32 v[184:185], v[182:183], v[182:183] op_sel_hi:[1,0]
    v_pk_fma_f32 v[176:177], v[174:175], v[174:175], v[176:177] op_sel:[1,1,0] op_sel_hi:[0,1,1] neg_lo:[1,0,0]
    v_pk_fma_f32 v[184:185], v[182:183], v[182:183], v[184:185] op_sel:[1,1,0] op_sel_hi:[0,1,1] neg_lo:[1,0,0]
    v_pk_mul_f32 v[178:179], v[176:177], v[176:177] op_sel_hi:[1,0]
    v_pk_fma_f32 v[178:179], v[176:177], v[176:177], v[178:179] op_sel:[1,1,0] op_sel_hi:[0,1,1] neg_lo:[1,0,0]
    v_cndmask_b32 v186, v172, v174, s[14:15]
    v_cndmask_b32 v187, v173, v175, s[14:15]
    v_cndmask_b32 v188, 1.0, v180, s[14:15]
    v_cndmask_b32 v189, 0, v181, s[14:15]
    v_cndmask_b32 v182, 1.0, v182, s[14:15]
    v_cndmask_b32 v183, 0, v183, s[14:15]
    v_pk_mul_f32 v[196:197], v[170:171], v[182:183] op_sel_hi:[1,0]
    v_pk_fma_f32 v[196:197], v[170:171], v[182:183], v[196:197] op_sel:[1,1,0] op_sel_hi:[0,1,1] neg_lo:[1,0,0]
    s_mov_b32 m0, s88
    v_cvt_pk_bf16_f32 v204, v188, v189
    v_cvt_pk_bf16_f32 v220, v196, -v197
    v_pk_mul_f32 v[190:191], v[188:189], v[178:179] op_sel_hi:[1,0]
    ds_write_addtid_b32 v204 offset:32768
    v_pk_mul_f32 v[192:193], v[196:197], v[186:187] op_sel_hi:[1,0]
    v_pk_fma_f32 v[190:191], v[188:189], v[178:179], v[190:191] op_sel:[1,1,0] op_sel_hi:[0,1,1] neg_lo:[1,0,0]
    v_pk_fma_f32 v[192:193], v[196:197], v[186:187], v[192:193] op_sel:[1,1,0] op_sel_hi:[0,1,1] neg_lo:[1,0,0]
    v_cvt_pk_bf16_f32 v205, v190, v191
    v_cvt_pk_bf16_f32 v222, v192, -v193
    ds_write_addtid_b32 v220 offset:41216
    v_pk_mul_f32 v[188:189], v[190:191], v[178:179] op_sel_hi:[1,0]
    ds_write_addtid_b32 v205 offset:33296
    v_pk_mul_f32 v[194:195], v[192:193], v[186:187] op_sel_hi:[1,0]
    v_pk_fma_f32 v[188:189], v[190:191], v[178:179], v[188:189] op_sel:[1,1,0] op_sel_hi:[0,1,1] neg_lo:[1,0,0]
    v_pk_fma_f32 v[194:195], v[192:193], v[186:187], v[194:195] op_sel:[1,1,0] op_sel_hi:[0,1,1] neg_lo:[1,0,0]
    v_cvt_pk_bf16_f32 v206, v188, v189
    v_cvt_pk_bf16_f32 v224, v194, -v195
    ds_write_addtid_b32 v222 offset:42272
    v_pk_mul_f32 v[190:191], v[188:189], v[178:179] op_sel_hi:[1,0]
    ds_write_addtid_b32 v206 offset:33824
    v_pk_mul_f32 v[192:193], v[194:195], v[186:187] op_sel_hi:[1,0]
    v_pk_fma_f32 v[190:191], v[188:189], v[178:179], v[190:191] op_sel:[1,1,0] op_sel_hi:[0,1,1] neg_lo:[1,0,0]
    v_pk_fma_f32 v[192:193], v[194:195], v[186:187], v[192:193] op_sel:[1,1,0] op_sel_hi:[0,1,1] neg_lo:[1,0,0]
    v_cvt_pk_bf16_f32 v207, v190, v191
    v_cvt_pk_bf16_f32 v226, v192, -v193
    ds_write_addtid_b32 v224 offset:43328
    v_pk_mul_f32 v[188:189], v[190:191], v[178:179] op_sel_hi:[1,0]
    ds_write_addtid_b32 v207 offset:34352
    v_pk_mul_f32 v[194:195], v[192:193], v[186:187] op_sel_hi:[1,0]
    v_pk_fma_f32 v[188:189], v[190:191], v[178:179], v[188:189] op_sel:[1,1,0] op_sel_hi:[0,1,1] neg_lo:[1,0,0]
    v_pk_fma_f32 v[194:195], v[192:193], v[186:187], v[194:195] op_sel:[1,1,0] op_sel_hi:[0,1,1] neg_lo:[1,0,0]
    v_cvt_pk_bf16_f32 v208, v188, v189
    v_cvt_pk_bf16_f32 v228, v194, -v195
    ds_write_addtid_b32 v226 offset:44384
    v_pk_mul_f32 v[190:191], v[188:189], v[178:179] op_sel_hi:[1,0]
    ds_write_addtid_b32 v208 offset:34880
    v_pk_mul_f32 v[192:193], v[194:195], v[186:187] op_sel_hi:[1,0]
    v_pk_fma_f32 v[190:191], v[188:189], v[178:179], v[190:191] op_sel:[1,1,0] op_sel_hi:[0,1,1] neg_lo:[1,0,0]
    v_pk_fma_f32 v[192:193], v[194:195], v[186:187], v[192:193] op_sel:[1,1,0] op_sel_hi:[0,1,1] neg_lo:[1,0,0]
    v_cvt_pk_bf16_f32 v209, v190, v191
    v_cvt_pk_bf16_f32 v230, v192, -v193
    ds_write_addtid_b32 v228 offset:45440
    v_pk_mul_f32 v[188:189], v[190:191], v[178:179] op_sel_hi:[1,0]
    ds_write_addtid_b32 v209 offset:35408
    v_pk_mul_f32 v[194:195], v[192:193], v[186:187] op_sel_hi:[1,0]
    v_pk_fma_f32 v[188:189], v[190:191], v[178:179], v[188:189] op_sel:[1,1,0] op_sel_hi:[0,1,1] neg_lo:[1,0,0]
    v_pk_fma_f32 v[194:195], v[192:193], v[186:187], v[194:195] op_sel:[1,1,0] op_sel_hi:[0,1,1] neg_lo:[1,0,0]
    v_cvt_pk_bf16_f32 v210, v188, v189
    v_cvt_pk_bf16_f32 v232, v194, -v195
    ds_write_addtid_b32 v230 offset:46496
    v_pk_mul_f32 v[190:191], v[188:189], v[178:179] op_sel_hi:[1,0]
    ds_write_addtid_b32 v210 offset:35936
    v_pk_mul_f32 v[192:193], v[194:195], v[186:187] op_sel_hi:[1,0]
    v_pk_fma_f32 v[190:191], v[188:189], v[178:179], v[190:191] op_sel:[1,1,0] op_sel_hi:[0,1,1] neg_lo:[1,0,0]
    v_pk_fma_f32 v[192:193], v[194:195], v[186:187], v[192:193] op_sel:[1,1,0] op_sel_hi:[0,1,1] neg_lo:[1,0,0]
    v_cvt_pk_bf16_f32 v211, v190, v191
    v_cvt_pk_bf16_f32 v234, v192, -v193
    ds_write_addtid_b32 v232 offset:47552
    v_pk_mul_f32 v[188:189], v[190:191], v[178:179] op_sel_hi:[1,0]
    ds_write_addtid_b32 v211 offset:36464
    v_pk_mul_f32 v[198:199], v[196:197], v[184:185] op_sel_hi:[1,0]
    v_pk_fma_f32 v[188:189], v[190:191], v[178:179], v[188:189] op_sel:[1,1,0] op_sel_hi:[0,1,1] neg_lo:[1,0,0]
    v_pk_fma_f32 v[198:199], v[196:197], v[184:185], v[198:199] op_sel:[1,1,0] op_sel_hi:[0,1,1] neg_lo:[1,0,0]
    v_cvt_pk_bf16_f32 v212, v188, v189
    v_cvt_pk_bf16_f32 v221, v198, -v199
    ds_write_addtid_b32 v234 offset:48608
    v_pk_mul_f32 v[190:191], v[188:189], v[178:179] op_sel_hi:[1,0]
    ds_write_addtid_b32 v212 offset:36992
    v_pk_mul_f32 v[194:195], v[198:199], v[176:177] op_sel_hi:[1,0]
    v_pk_fma_f32 v[190:191], v[188:189], v[178:179], v[190:191] op_sel:[1,1,0] op_sel_hi:[0,1,1] neg_lo:[1,0,0]
    v_pk_fma_f32 v[194:195], v[198:199], v[176:177], v[194:195] op_sel:[1,1,0] op_sel_hi:[0,1,1] neg_lo:[1,0,0]
    v_cvt_pk_bf16_f32 v213, v190, v191
    v_cvt_pk_bf16_f32 v223, v194, -v195
    ds_write_addtid_b32 v221 offset:41744
    v_pk_mul_f32 v[188:189], v[190:191], v[178:179] op_sel_hi:[1,0]
    ds_write_addtid_b32 v213 offset:37520
    v_pk_mul_f32 v[192:193], v[198:199], v[178:179] op_sel_hi:[1,0]
    v_pk_fma_f32 v[188:189], v[190:191], v[178:179], v[188:189] op_sel:[1,1,0] op_sel_hi:[0,1,1] neg_lo:[1,0,0]
    v_pk_fma_f32 v[192:193], v[198:199], v[178:179], v[192:193] op_sel:[1,1,0] op_sel_hi:[0,1,1] neg_lo:[1,0,0]
    v_cvt_pk_bf16_f32 v214, v188, v189
    v_cvt_pk_bf16_f32 v225, v192, -v193
    ds_write_addtid_b32 v223 offset:42800
    v_pk_mul_f32 v[190:191], v[188:189], v[178:179] op_sel_hi:[1,0]
    ds_write_addtid_b32 v214 offset:38048
    v_pk_mul_f32 v[200:201], v[198:199], v[184:185] op_sel_hi:[1,0]
    v_pk_fma_f32 v[190:191], v[188:189], v[178:179], v[190:191] op_sel:[1,1,0] op_sel_hi:[0,1,1] neg_lo:[1,0,0]
    v_pk_fma_f32 v[200:201], v[198:199], v[184:185], v[200:201] op_sel:[1,1,0] op_sel_hi:[0,1,1] neg_lo:[1,0,0]
    v_cvt_pk_bf16_f32 v215, v190, v191
    v_cvt_pk_bf16_f32 v227, v200, -v201
    ds_write_addtid_b32 v225 offset:43856
    v_pk_mul_f32 v[188:189], v[190:191], v[178:179] op_sel_hi:[1,0]
    ds_write_addtid_b32 v215 offset:38576
    v_pk_mul_f32 v[194:195], v[200:201], v[178:179] op_sel_hi:[1,0]
    v_pk_fma_f32 v[188:189], v[190:191], v[178:179], v[188:189] op_sel:[1,1,0] op_sel_hi:[0,1,1] neg_lo:[1,0,0]
    v_pk_fma_f32 v[194:195], v[200:201], v[178:179], v[194:195] op_sel:[1,1,0] op_sel_hi:[0,1,1] neg_lo:[1,0,0]
    v_cvt_pk_bf16_f32 v216, v188, v189
    v_cvt_pk_bf16_f32 v229, v194, -v195
    ds_write_addtid_b32 v227 offset:44912
    v_pk_mul_f32 v[190:191], v[188:189], v[178:179] op_sel_hi:[1,0]
    ds_write_addtid_b32 v216 offset:39104
    v_pk_mul_f32 v[198:199], v[200:201], v[184:185] op_sel_hi:[1,0]
    v_pk_fma_f32 v[190:191], v[188:189], v[178:179], v[190:191] op_sel:[1,1,0] op_sel_hi:[0,1,1] neg_lo:[1,0,0]
    v_pk_fma_f32 v[198:199], v[200:201], v[184:185], v[198:199] op_sel:[1,1,0] op_sel_hi:[0,1,1] neg_lo:[1,0,0]
    v_cvt_pk_bf16_f32 v217, v190, v191
    v_cvt_pk_bf16_f32 v231, v198, -v199
    ds_write_addtid_b32 v229 offset:45968
    v_pk_mul_f32 v[188:189], v[190:191], v[178:179] op_sel_hi:[1,0]
    ds_write_addtid_b32 v217 offset:39632
    v_pk_mul_f32 v[192:193], v[198:199], v[178:179] op_sel_hi:[1,0]
    v_pk_fma_f32 v[188:189], v[190:191], v[178:179], v[188:189] op_sel:[1,1,0] op_sel_hi:[0,1,1] neg_lo:[1,0,0]
    v_pk_fma_f32 v[192:193], v[198:199], v[178:179], v[192:193] op_sel:[1,1,0] op_sel_hi:[0,1,1] neg_lo:[1,0,0]
    v_cvt_pk_bf16_f32 v218, v188, v189
    v_cvt_pk_bf16_f32 v233, v192, -v193
    ds_write_addtid_b32 v231 offset:47024
    v_pk_mul_f32 v[190:191], v[188:189], v[178:179] op_sel_hi:[1,0]
    ds_write_addtid_b32 v218 offset:40160
    v_pk_fma_f32 v[190:191], v[188:189], v[178:179], v[190:191] op_sel:[1,1,0] op_sel_hi:[0,1,1] neg_lo:[1,0,0]
    v_cvt_pk_bf16_f32 v219, v190, v191
    ds_write_addtid_b32 v233 offset:48080
    ds_write_addtid_b32 v219 offset:40688
    s_cmp_ge_u32 s3, 4
    s_cbranch_scc1 Lr1_6
    s_waitcnt lgkmcnt(0)
    s_barrier
    s_lshl_b32 s10, s3, 8
    s_add_u32 s11, s10, 0
    v_add_u32 v10, s11, v23
    s_add_u32 s11, s10, 98304
    v_add_u32 v11, s11, v23
    ds_read_b64_tr_b16 v[64:65], v10 offset:0
    ds_read_b64_tr_b16 v[66:67], v11 offset:0
    ds_read_b64_tr_b16 v[68:69], v10 offset:32
    ds_read_b64_tr_b16 v[70:71], v11 offset:32
    ds_read_b64_tr_b16 v[72:73], v10 offset:64
    ds_read_b64_tr_b16 v[74:75], v11 offset:64
    ds_read_b64_tr_b16 v[76:77], v10 offset:96
    ds_read_b64_tr_b16 v[78:79], v11 offset:96
    ds_read_b64_tr_b16 v[80:81], v10 offset:128
    ds_read_b64_tr_b16 v[82:83], v11 offset:128
    ds_read_b64_tr_b16 v[84:85], v10 offset:160
    ds_read_b64_tr_b16 v[86:87], v11 offset:160
    ds_read_b64_tr_b16 v[88:89], v10 offset:192
    ds_read_b64_tr_b16 v[90:91], v11 offset:192
    ds_read_b64_tr_b16 v[92:93], v10 offset:224
    ds_read_b64_tr_b16 v[94:95], v11 offset:224
    s_lshl_b32 s10, s3, 19
    s_add_u32 s10, s10, s25
    s_waitcnt lgkmcnt(14)
    s_add_u32 s13, s10, 0
    buffer_store_dwordx4 v[64:67], v8, s[64:67], s13 offen sc1
    s_waitcnt lgkmcnt(12)
    s_add_u32 s13, s10, 65536
    buffer_store_dwordx4 v[68:71], v8, s[64:67], s13 offen sc1
    s_waitcnt lgkmcnt(10)
    s_add_u32 s13, s10, 131072
    buffer_store_dwordx4 v[72:75], v8, s[64:67], s13 offen sc1
    s_waitcnt lgkmcnt(8)
    s_add_u32 s13, s10, 196608
    buffer_store_dwordx4 v[76:79], v8, s[64:67], s13 offen sc1
    s_waitcnt lgkmcnt(6)
    s_add_u32 s13, s10, 262144
    buffer_store_dwordx4 v[80:83], v8, s[64:67], s13 offen sc1
    s_waitcnt lgkmcnt(4)
    s_add_u32 s13, s10, 327680
    buffer_store_dwordx4 v[84:87], v8, s[64:67], s13 offen sc1
    s_waitcnt lgkmcnt(2)
    s_add_u32 s13, s10, 393216
    buffer_store_dwordx4 v[88:91], v8, s[64:67], s13 offen sc1
    s_waitcnt lgkmcnt(0)
    s_add_u32 s13, s10, 458752
    buffer_store_dwordx4 v[92:95], v8, s[64:67], s13 offen sc1
Lr1_6:
    s_waitcnt lgkmcnt(0)
    s_barrier
    ds_read_b128 v[160:163], v152 offset:0
    ds_read_b128 v[164:167], v153 offset:0
    ds_read_b128 v[168:171], v152 offset:16
    ds_read_b128 v[172:175], v153 offset:16
    ds_read_b128 v[176:179], v152 offset:32
    ds_read_b128 v[180:183], v153 offset:32
    ds_read_b128 v[184:187], v152 offset:48
    ds_read_b128 v[188:191], v153 offset:48
    ds_read_b128 v[192:195], v152 offset:64
    ds_read_b128 v[196:199], v153 offset:64
    ds_read_b128 v[200:203], v152 offset:80
    ds_read_b128 v[204:207], v153 offset:80
    ds_read_b128 v[208:211], v152 offset:96
    ds_read_b128 v[212:215], v153 offset:96
    ds_read_b128 v[216:219], v152 offset:112
    ds_read_b128 v[220:223], v153 offset:112
    v_and_b32 v21, 7, v0
    v_lshlrev_b32 v21, 4, v21
    s_waitcnt lgkmcnt(14)
    v_mfma_f32_16x16x32_bf16 v[236:239], v[160:163], v[164:167], 0
    s_waitcnt lgkmcnt(12)
    v_mfma_f32_16x16x32_bf16 v[236:239], v[168:171], v[172:175], v[236:239]
    s_waitcnt lgkmcnt(10)
    v_mfma_f32_16x16x32_bf16 v[236:239], v[176:179], v[180:183], v[236:239]
    s_waitcnt lgkmcnt(8)
    v_mfma_f32_16x16x32_bf16 v[236:239], v[184:187], v[188:191], v[236:239]
    s_waitcnt lgkmcnt(6)
    v_mfma_f32_16x16x32_bf16 v[236:239], v[192:195], v[196:199], v[236:239]
    s_waitcnt lgkmcnt(4)
    v_mfma_f32_16x16x32_bf16 v[236:239], v[200:203], v[204:207], v[236:239]
    s_waitcnt lgkmcnt(2)
    v_mfma_f32_16x16x32_bf16 v[236:239], v[208:211], v[212:215], v[236:239]
    s_waitcnt lgkmcnt(0)
    v_mfma_f32_16x16x32_bf16 v[236:239], v[216:219], v[220:223], v[236:239]
    s_cmp_ge_u32 s3, 4
    s_cbranch_scc0 Lr1_8
    s_waitcnt vmcnt(0)
    s_cmp_lg_u32 s3, 4
    s_cbranch_scc1 Low_10
    ds_write_b128 v20, v[28:31] offset:16640
Low_10:
    s_waitcnt lgkmcnt(0)
Lr1_8:
    s_barrier
    global_load_dwordx2 v[250:251], v235, s[46:47] sc1
    s_lshl_b32 s10, s3, 7
    s_add_u32 s11, s10, 114944
    v_add_u32 v10, s11, v23
    s_add_u32 s11, s10, 131584
    v_add_u32 v11, s11, v23
    ds_read_b64_tr_b16 v[64:65], v10 offset:0
    ds_read_b64_tr_b16 v[66:67], v11 offset:0
    ds_read_b64_tr_b16 v[68:69], v10 offset:32
    ds_read_b64_tr_b16 v[70:71], v11 offset:32
    ds_read_b64_tr_b16 v[72:73], v10 offset:64
    ds_read_b64_tr_b16 v[74:75], v11 offset:64
    ds_read_b64_tr_b16 v[76:77], v10 offset:96
    ds_read_b64_tr_b16 v[78:79], v11 offset:96
    s_lshl_b32 s10, s3, 18
    s_add_u32 s10, s10, s25
    s_waitcnt lgkmcnt(6)
    s_add_u32 s13, s10, 128
    buffer_store_dwordx4 v[64:67], v8, s[64:67], s13 offen sc1
    s_waitcnt lgkmcnt(4)
    s_add_u32 s13, s10, 65664
    buffer_store_dwordx4 v[68:71], v8, s[64:67], s13 offen sc1
    s_waitcnt lgkmcnt(2)
    s_add_u32 s13, s10, 131200
    buffer_store_dwordx4 v[72:75], v8, s[64:67], s13 offen sc1
    s_waitcnt lgkmcnt(0)
    s_add_u32 s13, s10, 196736
    buffer_store_dwordx4 v[76:79], v8, s[64:67], s13 offen sc1
    v_lshrrev_b32 v9, 3, v1
    v_mul_u32_u24 v10, 1040, v9
    v_add3_u32 v10, v10, v21, s8
    v_lshrrev_b32 v9, 3, v0
    ds_read_b128 v[96:99], v10 offset:0
    ds_read_b128 v[24:27], v21 offset:16640
    ds_read_b128 v[100:103], v10 offset:128
    ds_read_b128 v[28:31], v21 offset:16768
    ds_read_b128 v[104:107], v10 offset:256
    ds_read_b128 v[32:35], v21 offset:16896
    ds_read_b128 v[108:111], v10 offset:384
    ds_read_b128 v[36:39], v21 offset:17024
    ds_read_b128 v[112:115], v10 offset:512
    ds_read_b128 v[40:43], v21 offset:17152
    ds_read_b128 v[116:119], v10 offset:640
    ds_read_b128 v[44:47], v21 offset:17280
    ds_read_b128 v[120:123], v10 offset:768
    ds_read_b128 v[48:51], v21 offset:17408
    ds_read_b128 v[124:127], v10 offset:896
    ds_read_b128 v[52:55], v21 offset:17536
    s_cmp_ge_u32 s3, 4
    s_cbranch_scc1 Lr1_11
    v_cvt_pk_bf16_f32 v160, v236, v237
    v_cvt_pk_bf16_f32 v161, v238, v239
    ds_write_b64 v154, v[160:161]
    s_branch Lr2_12
Lr1_11:
    s_mov_b32 s14, 0xaaaaaaaa
    s_mov_b32 s15, 0xaaaaaaaa
    v_cndmask_b32 v172, v236, v237, s[14:15]
    v_cndmask_b32 v173, v238, v239, s[14:15]
    v_cvt_pk_bf16_f32 v160, v236, v236
    v_cvt_pk_bf16_f32 v161, v236, v236
    v_cvt_pk_bf16_f32 v162, v172, v237
    v_cvt_pk_bf16_f32 v163, v237, v237
    v_cvt_pk_bf16_f32 v164, v238, v238
    v_cvt_pk_bf16_f32 v165, v238, v238
    v_cvt_pk_bf16_f32 v166, v173, v239
    v_cvt_pk_bf16_f32 v167, v239, v239
    s_mov_b64 exec, 0xffffffff
    v_cvt_pk_bf16_f32 v161, v236, v237
    v_mov_b32 v162, v163
    v_mov_b32 v163, v164
    s_not_b64 exec, exec
    ds_write_b128 v154, v[164:167] offset:1024
    s_mov_b64 exec, -1
    ds_write_b128 v154, v[160:163]
Lr2_12:
    s_cmp_lg_u32 s3, 0
    s_cbranch_scc1 Low_13
    v_mov_b32 v176, 0
    v_bfe_u32 v177, v1, 4, 1
    v_and_b32 v178, 15, v1
    v_mul_u32_u24 v179, 4160, v177
    v_lshl_add_u32 v179, v178, 2, v179
    v_mul_u32_u24 v180, 2064, v177
    v_lshl_add_u32 v180, v178, 2, v180
    v_lshlrev_b32 v181, 2, v1
    s_mov_b64 exec, 0xffffffff
    ds_write_b32 v179, v176 offset:49152
    ds_write_b32 v180, v176 offset:57472
    ds_write_b32 v181, v176 offset:65408
    s_mov_b64 exec, -1
Low_13:
    s_cmp_lg_u32 s3, 1
    s_cbranch_scc1 Low_14
    v_mov_b32 v236, 0
    v_mov_b32 v237, 0
    v_mov_b32 v238, 0
    v_mov_b32 v239, 0
    v_and_b32 v233, 31, v1
    v_lshlrev_b32 v233, 4, v233
    v_lshrrev_b32 v234, 5, v1
    v_mul_u32_u24 v234, 4608, v234
    v_add_u32 v233, v233, v234
    ds_write_b128 v233, v[236:239] offset:32768
Low_14:
    v_mov_b32 v11, 0
    v_mov_b32 v12, 0
    s_waitcnt lgkmcnt(0)
    v_dot2_f32_bf16 v11, v24, v96, v11
    v_dot2_f32_bf16 v12, v25, v97, v12
    v_dot2_f32_bf16 v11, v26, v98, v11
    v_dot2_f32_bf16 v12, v27, v99, v12
    v_dot2_f32_bf16 v11, v28, v100, v11
    v_dot2_f32_bf16 v12, v29, v101, v12
    v_dot2_f32_bf16 v11, v30, v102, v11
    v_dot2_f32_bf16 v12, v31, v103, v12
    v_dot2_f32_bf16 v11, v32, v104, v11
    v_dot2_f32_bf16 v12, v33, v105, v12
    v_dot2_f32_bf16 v11, v34, v106, v11
    v_dot2_f32_bf16 v12, v35, v107, v12
    v_dot2_f32_bf16 v11, v36, v108, v11
    v_dot2_f32_bf16 v12, v37, v109, v12
    v_dot2_f32_bf16 v11, v38, v110, v11
    v_dot2_f32_bf16 v12, v39, v111, v12
    v_dot2_f32_bf16 v11, v40, v112, v11
    v_dot2_f32_bf16 v12, v41, v113, v12
    v_dot2_f32_bf16 v11, v42, v114, v11
    v_dot2_f32_bf16 v12, v43, v115, v12
    v_dot2_f32_bf16 v11, v44, v116, v11
    v_dot2_f32_bf16 v12, v45, v117, v12
    v_dot2_f32_bf16 v11, v46, v118, v11
    v_dot2_f32_bf16 v12, v47, v119, v12
    v_dot2_f32_bf16 v11, v48, v120, v11
    v_dot2_f32_bf16 v12, v49, v121, v12
    v_dot2_f32_bf16 v11, v50, v122, v11
    v_dot2_f32_bf16 v12, v51, v123, v12
    v_dot2_f32_bf16 v11, v52, v124, v11
    v_dot2_f32_bf16 v12, v53, v125, v12
    v_dot2_f32_bf16 v11, v54, v126, v11
    v_dot2_f32_bf16 v12, v55, v127, v12
    s_nop 2
    v_add_f32 v11, v11, v12
    s_nop 1
    v_add_f32_dpp v11, v11, v11 quad_perm:[1,0,3,2] row_mask:0xf bank_mask:0xf
    s_nop 1
    v_add_f32_dpp v11, v11, v11 quad_perm:[2,3,0,1] row_mask:0xf bank_mask:0xf
    s_nop 1
    v_add_f32_dpp v11, v11, v11 row_half_mirror row_mask:0xf bank_mask:0xf
    v_mul_f32 v11, 0xbfb8aa3b, v11
    v_exp_f32 v11, v11
    s_nop 0
    v_add_f32 v11, 1.0, v11
    v_rcp_f32 v11, v11
    v_lshlrev_b32 v9, 2, v9
    s_waitcnt vmcnt(0)
Lnok_15r:
    v_readfirstlane_b32 s10, v251
    v_readfirstlane_b32 s76, v250
    s_cmp_lg_u32 s10, 1
    s_cbranch_scc1 Lnlp_16
Lnok_15:
    s_barrier
    s_cmp_lg_u32 s3, 1
    s_cbranch_scc1 Low_17
    s_lshl_b32 s10, s6, 2
    s_add_u32 s10, s10, 12648448
    v_mov_b32 v250, 0
    v_mov_b32 v251, s76
    s_mov_b64 exec, 1
    buffer_store_dword v251, v250, s[64:67], s10 offen sc1
    s_mov_b64 exec, -1
Low_17:
    s_lshl_b32 s13, s6, 8
    s_add_u32 s13, s13, 12582912
    v_cmp_eq_u32 vcc, 0, v21
    s_nop 0
    s_mov_b64 exec, vcc
    buffer_store_dword v11, v9, s[64:67], s13 offen sc1
    s_mov_b64 exec, -1
    s_lshl_b32 s101, s6, 13
    s_lshl_b32 s11, s3, 10
    s_add_u32 s101, s101, s11
    buffer_load_dwordx4 v[52:55], v20, s[68:71], s101 offen
    s_add_u32 s101, s101, 262144
    buffer_load_dwordx4 v[52:55], v20, s[68:71], s101 offen
    s_add_u32 s101, s101, 262144
    buffer_load_dwordx4 v[52:55], v20, s[68:71], s101 offen
    s_add_u32 s101, s101, 262144
    buffer_load_dwordx4 v[52:55], v20, s[68:71], s101 offen
    s_add_u32 s101, s101, 262144
    buffer_load_dwordx4 v[52:55], v20, s[68:71], s101 offen
    s_add_u32 s101, s101, 262144
    s_bfe_u32 s10, s3, 0x10001
    v_lshrrev_b32 v14, 5, v1
    v_lshlrev_b32 v2, 6, v14
    v_and_b32 v15, 31, v1
    v_lshlrev_b32 v3, 4, v15
    v_sub_u32 v3, v3, v2
    v_and_b32 v16, 1, v1
    v_lshl_add_u32 v2, v16, 5, v2
    v_lshrrev_b32 v15, 2, v15
    v_lshl_add_u32 v15, v15, 1, v14
    v_lshlrev_b32 v5, 5, v15
    v_lshl_add_u32 v5, v16, 4, v5
    s_mul_i32 s11, s10, 2064
    s_add_u32 s11, s11, 57472
    v_lshl_add_u32 v4, v15, 4, s11
    v_bfe_u32 v16, v1, 4, 1
    v_lshl_add_u32 v2, v16, 4, v2
    v_bfe_u32 v16, v1, 1, 1
    v_lshl_add_u32 v2, v16, 3, v2
    v_bfe_u32 v16, v1, 2, 2
    v_lshlrev_b32 v16, 3, v16
    v_sub_u32 v2, v2, v16
    s_mul_i32 s11, s10, 4160
    s_add_u32 s11, s11, 49184
    v_add_u32 v2, s11, v2
    s_mul_i32 s11, s10, 4608
    s_add_u32 s11, s11, 32896
    v_add_u32 v3, s11, v3
    s_lshl_b32 s11, s2, 1
    s_add_u32 s11, s11, s10
    s_lshl_b32 s11, s11, 12
    s_add_u32 s89, s11, 10485760
    s_and_b32 s80, s4, 6
    s_lshl_b32 s80, s80, 2
    s_and_b32 s10, s5, 7
    s_add_u32 s80, s80, s10
    s_and_b32 s81, s4, 1
    s_lshl_b32 s81, s81, 2
    s_lshr_b32 s10, s5, 3
    s_add_u32 s81, s81, s10
    s_lshr_b32 s82, s3, 2
    s_and_b32 s83, s3, 3
    s_lshl_b32 s10, s80, 1
    s_and_b32 s13, s3, 1
    s_add_u32 s10, s10, s13
    s_mul_i32 s11, s10, 112
    s_lshr_b32 s12, s3, 1
    s_mul_i32 s100, s12, 458752
    s_lshl_b32 s13, s13, 15
    s_add_u32 s100, s100, s13
    s_mul_i32 s13, s12, 28
    s_add_u32 s11, s11, s13
    s_lshl_b32 s84, s11, 10
    s_lshl_b32 s51, s10, 7
    s_add_u32 s51, s51, 12582912
    s_lshl_b32 s10, s10, 15
    s_lshl_b32 s11, s81, 7
    s_lshl_b32 s12, s12, 5
    s_add_u32 s50, s11, s12
    s_add_u32 s85, s10, s50
    s_mul_i32 s90, s83, 458752
    s_lshl_b32 s91, s83, 13
    s_mov_b32 s44, 0x6543210
    s_mov_b32 s45, 0x10654321
    s_and_b32 s10, s5, 7
    s_lshl_b32 s10, s10, 2
    s_lshr_b64 s[44:45], s[44:45], s10
    s_bfe_u32 s10, s44, 0x30000
    s_lshl_b32 s36, s10, 12
    s_bfe_u32 s10, s44, 0x30004
    s_lshl_b32 s37, s10, 12
    s_bfe_u32 s10, s44, 0x30008
    s_lshl_b32 s38, s10, 12
    s_bfe_u32 s10, s44, 0x3000c
    s_lshl_b32 s39, s10, 12
    s_bfe_u32 s10, s44, 0x30010
    s_lshl_b32 s40, s10, 12
    s_bfe_u32 s10, s44, 0x30014
    s_lshl_b32 s41, s10, 12
    s_bfe_u32 s10, s44, 0x30018
    s_lshl_b32 s42, s10, 12
    v_lshlrev_b32 v240, 4, v1
    v_lshrrev_b32 v14, 3, v1
    v_lshlrev_b32 v14, 10, v14
    v_bfe_u32 v15, v1, 4, 1
    v_lshlrev_b32 v15, 2, v15
    v_and_b32 v16, 7, v1
    v_xor_b32 v16, v16, v15
    v_lshl_add_u32 v14, v16, 4, v14
    v_add_u32 v241, s11, v14
    v_lshrrev_b32 v14, 5, v1
    v_bfe_u32 v15, v1, 2, 2
    v_lshl_add_u32 v14, v14, 2, v15
    v_lshlrev_b32 v14, 7, v14
    v_bfe_u32 v15, v1, 3, 1
    v_lshl_add_u32 v14, v15, 6, v14
    v_bfe_u32 v15, v1, 4, 1
    v_lshl_add_u32 v14, v15, 5, v14
    v_and_b32 v15, 1, v1
    v_lshl_add_u32 v14, v15, 4, v14
    v_bfe_u32 v15, v1, 1, 1
    v_lshl_add_u32 v14, v15, 3, v14
    v_xor_b32 v14, s12, v14
    s_lshl_b32 s12, s12, 8
    v_add_u32 v242, s12, v14
    s_lshl_b32 s10, s3, 2
    s_add_u32 s10, s10, 65408
    v_mov_b32 v243, s10
    buffer_load_dwordx4 v[52:55], v20, s[68:71], s101 offen
    s_add_u32 s101, s101, 262144
    buffer_load_dwordx4 v[52:55], v20, s[68:71], s101 offen
    s_add_u32 s101, s101, 262144
    s_cmp_lg_u32 s3, 0
    s_cbranch_scc1 Low_18
    s_mov_b32 s79, 12648448
    v_min_u32 v252, 31, v1
    v_lshlrev_b32 v252, 2, v252
    buffer_load_dword v249, v252, s[64:67], s79 offen sc1
    s_waitcnt vmcnt(0)
Lpok_19r:
    v_cmp_ne_u32 vcc, s76, v249
    s_nop 0
    s_cmp_lg_u64 vcc, 0
    s_cbranch_scc1 Lplp_20
Lpok_19:
Low_18:
    s_waitcnt vmcnt(7)
    s_barrier
    s_cmp_lg_u32 s3, 1
    s_cbranch_scc1 Low_21
    s_lshl_b32 s10, s6, 2
    s_add_u32 s10, s10, 12660736
    v_mov_b32 v250, 0
    v_mov_b32 v251, s76
    s_mov_b64 exec, 1
    buffer_store_dword v251, v250, s[64:67], s10 offen sc1
    s_mov_b64 exec, -1
Low_21:
    s_cmp_ge_u32 s3, 4
    s_cbranch_scc0 Lr1_22
    v_lshlrev_b32 v248, 5, v1
    s_lshl_b32 s10, s2, 13
    s_lshl_b32 s11, s83, 11
    s_add_u32 s10, s10, s11
    s_add_u32 s10, s10, 8388608
    buffer_load_dwordx4 v[244:247], v248, s[64:67], s10 offen sc1
    buffer_load_dwordx4 v[156:159], v248, s[64:67], s10 offen offset:16 sc1
Lr1_22:
    v_and_b32 v64, 31, v1
    v_lshrrev_b32 v65, 5, v1
    v_lshlrev_b32 v66, 4, v65
    v_lshl_add_u32 v64, v64, 10, v66
    buffer_load_dwordx4 v[56:59], v64, s[52:55], s85 offen
    v_add_u32 v66, s50, v66
    global_load_dwordx4 v[60:63], v66, s[32:33]
    s_waitcnt vmcnt(0)
    s_cmp_ge_u32 s3, 4
    s_cbranch_scc0 Lr1_24
    s_lshl_b32 s11, s83, 10
    v_add_u32 v248, s11, v240
    ds_write_b128 v248, v[244:247] offset:33280
    ds_write_b128 v248, v[156:159] offset:37888
Lr1_24:
    v_lshlrev_b32 v64, 16, v56
    v_lshlrev_b32 v65, 16, v60
    v_and_b32 v56, 0xffff0000, v56
    v_and_b32 v60, 0xffff0000, v60
    v_mul_f32 v64, v64, v65
    v_mul_f32 v65, v56, v60
    v_cvt_pk_bf16_f32 v244, v64, v65
    v_lshlrev_b32 v64, 16, v57
    v_lshlrev_b32 v65, 16, v61
    v_and_b32 v57, 0xffff0000, v57
    v_and_b32 v61, 0xffff0000, v61
    v_mul_f32 v64, v64, v65
    v_mul_f32 v65, v57, v61
    v_cvt_pk_bf16_f32 v245, v64, v65
    v_lshlrev_b32 v64, 16, v58
    v_lshlrev_b32 v65, 16, v62
    v_and_b32 v58, 0xffff0000, v58
    v_and_b32 v62, 0xffff0000, v62
    v_mul_f32 v64, v64, v65
    v_mul_f32 v65, v58, v62
    v_cvt_pk_bf16_f32 v246, v64, v65
    v_lshlrev_b32 v64, 16, v59
    v_lshlrev_b32 v65, 16, v63
    v_and_b32 v59, 0xffff0000, v59
    v_and_b32 v63, 0xffff0000, v63
    v_mul_f32 v64, v64, v65
    v_mul_f32 v65, v59, v63
    v_cvt_pk_bf16_f32 v247, v64, v65
    s_waitcnt lgkmcnt(0)
    s_barrier
    v_mov_b32 v6, 1
    v_mov_b32 v7, 65408
    s_lshl_b32 s10, s83, 4
    s_add_u32 s10, s10, 65440
    v_mov_b32 v108, s10
    v_xor_b32 v109, 16, v108
    s_cmp_ge_u32 s3, 4
    s_cbranch_scc1 L_conv
    s_add_u32 m0, s91, 65536
    s_lshl_b32 s13, s36, 4
    s_add_u32 s13, s13, s90
    buffer_load_dwordx4 v241, s[68:71], s13 offen lds
    s_add_u32 m0, s91, 66560
    s_add_u32 s13, s13, 8192
    buffer_load_dwordx4 v241, s[68:71], s13 offen lds
    s_add_u32 m0, s91, 67584
    s_add_u32 s13, s13, 8192
    buffer_load_dwordx4 v241, s[68:71], s13 offen lds
    s_add_u32 m0, s91, 68608
    s_add_u32 s13, s13, 8192
    buffer_load_dwordx4 v241, s[68:71], s13 offen lds
    s_add_u32 m0, s91, 69632
    s_add_u32 s13, s13, 8192
    buffer_load_dwordx4 v241, s[68:71], s13 offen lds
    s_add_u32 m0, s91, 70656
    s_add_u32 s13, s13, 8192
    buffer_load_dwordx4 v241, s[68:71], s13 offen lds
    s_add_u32 m0, s91, 71680
    s_add_u32 s13, s13, 8192
    buffer_load_dwordx4 v241, s[68:71], s13 offen lds
    s_add_u32 m0, s91, 72704
    s_add_u32 s13, s13, 8192
    buffer_load_dwordx4 v241, s[68:71], s13 offen lds
    s_add_u32 m0, s91, 98304
    s_lshl_b32 s13, s37, 4
    s_add_u32 s13, s13, s90
    buffer_load_dwordx4 v241, s[68:71], s13 offen lds
    s_add_u32 m0, s91, 99328
    s_add_u32 s13, s13, 8192
    buffer_load_dwordx4 v241, s[68:71], s13 offen lds
    s_add_u32 m0, s91, 100352
    s_add_u32 s13, s13, 8192
    buffer_load_dwordx4 v241, s[68:71], s13 offen lds
    s_add_u32 m0, s91, 101376
    s_add_u32 s13, s13, 8192
    buffer_load_dwordx4 v241, s[68:71], s13 offen lds
    s_add_u32 m0, s91, 102400
    s_add_u32 s13, s13, 8192
    buffer_load_dwordx4 v241, s[68:71], s13 offen lds
    s_add_u32 m0, s91, 103424
    s_add_u32 s13, s13, 8192
    buffer_load_dwordx4 v241, s[68:71], s13 offen lds
    s_add_u32 m0, s91, 104448
    s_add_u32 s13, s13, 8192
    buffer_load_dwordx4 v241, s[68:71], s13 offen lds
    s_add_u32 m0, s91, 105472
    s_add_u32 s13, s13, 8192
    buffer_load_dwordx4 v241, s[68:71], s13 offen lds
    s_branch L_help
Lnlp_16:
    s_add_u32 s78, s78, 1
    s_cmp_ge_u32 s78, 2000000
    s_cbranch_scc1 Lnok_15
    s_sleep 2
    global_load_dwordx2 v[250:251], v235, s[46:47] sc1
    s_waitcnt vmcnt(0)
    s_branch Lnok_15r
Lplp_20:
    s_add_u32 s78, s78, 1
    s_cmp_ge_u32 s78, 2000000
    s_cbranch_scc1 Lpok_19
    s_sleep 8
    buffer_load_dword v249, v252, s[64:67], s79 offen sc1
    s_waitcnt vmcnt(0)
    s_branch Lpok_19r
Lnlp_29:
    s_add_u32 s78, s78, 1
    s_cmp_ge_u32 s78, 2000000
    s_cbranch_scc1 Lnok_28
    s_sleep 2
    global_load_dwordx2 v[250:251], v235, s[46:47] sc1
    s_waitcnt vmcnt(0)
    s_branch Lnok_28r
Lplp_32:
    s_add_u32 s78, s78, 1
    s_cmp_ge_u32 s78, 2000000
    s_cbranch_scc1 Lpok_31
    s_sleep 4
    buffer_load_dword v249, v252, s[64:67], s79 offen sc1
    s_waitcnt vmcnt(0)
    s_branch Lpok_31r
Lcsl_36:
Llw_53:
    ds_read_b32 v60, v109 offset:4
    s_add_u32 s78, s78, 1
    s_waitcnt lgkmcnt(0)
    v_cmp_eq_u32 vcc, 0, v60
    s_nop 0
    s_cmp_eq_u64 vcc, 0
    s_cbranch_scc1 Llok_54
    s_cmp_lt_u32 s78, 32000000
    s_cbranch_scc1 Llw_53
Llok_54:
    s_mov_b64 vcc, s[14:15]
    ds_read_b128 v[56:59], v4 offset:768
    s_waitcnt lgkmcnt(0)
    s_branch Lcok_35
Lcsl_38:
Llw_55:
    ds_read_b32 v100, v109 offset:12
    s_add_u32 s78, s78, 1
    s_waitcnt lgkmcnt(0)
    v_cmp_eq_u32 vcc, 0, v100
    s_nop 0
    s_cmp_eq_u64 vcc, 0
    s_cbranch_scc1 Llok_56
    s_cmp_lt_u32 s78, 32000000
    s_cbranch_scc1 Llw_55
Llok_56:
    s_mov_b64 vcc, s[14:15]
    ds_read_b128 v[96:99], v4 offset:1792
    s_waitcnt lgkmcnt(0)
    s_branch Lcok_37
Lcsl_40:
Llw_57:
    ds_read_b32 v40, v109 offset:0
    s_add_u32 s78, s78, 1
    s_waitcnt lgkmcnt(0)
    v_cmp_eq_u32 vcc, 0, v40
    s_nop 0
    s_cmp_eq_u64 vcc, 0
    s_cbranch_scc1 Llok_58
    s_cmp_lt_u32 s78, 32000000
    s_cbranch_scc1 Llw_57
Llok_58:
    s_mov_b64 vcc, s[14:15]
    ds_read_b128 v[36:39], v4 offset:256
    s_waitcnt lgkmcnt(0)
    s_branch Lcok_39
Lcsl_42:
Llw_59:
    ds_read_b32 v80, v109 offset:8
    s_add_u32 s78, s78, 1
    s_waitcnt lgkmcnt(0)
    v_cmp_eq_u32 vcc, 0, v80
    s_nop 0
    s_cmp_eq_u64 vcc, 0
    s_cbranch_scc1 Llok_60
    s_cmp_lt_u32 s78, 32000000
    s_cbranch_scc1 Llw_59
Llok_60:
    s_mov_b64 vcc, s[14:15]
    ds_read_b128 v[76:79], v4 offset:1280
    s_waitcnt lgkmcnt(0)
    s_branch Lcok_41
Lplp_47:
    s_add_u32 s78, s78, 1
    s_cmp_ge_u32 s78, 2000000
    s_cbranch_scc1 Lpok_46
    s_sleep 1
    buffer_load_dword v249, v252, s[64:67], s79 offen sc1
    s_waitcnt vmcnt(0)
    s_branch Lpok_46r
Lplp_49:
    s_add_u32 s78, s78, 1
    s_cmp_ge_u32 s78, 2000000
    s_cbranch_scc1 Lpok_48
    s_sleep 1
    buffer_load_dword v249, v252, s[64:67], s79 offen sc1
    s_waitcnt vmcnt(0)
    s_branch Lpok_48r
Lplp_52:
    s_add_u32 s78, s78, 1
    s_cmp_ge_u32 s78, 2000000
    s_cbranch_scc1 Lpok_51
    s_sleep 1
    buffer_load_dword v249, v252, s[64:67], s79 offen sc1
    s_waitcnt vmcnt(0)
    s_branch Lpok_51r
L_end:
    s_endpgm
.section .rodata,"a"
.p2align 6
.amdhsa_kernel gated_mix__ssm_conv_s4__glu_gated_bilinear__prompt_kernel
  .amdhsa_next_free_vgpr 256
  .amdhsa_next_free_sgpr 102
  .amdhsa_accum_offset 256
  .amdhsa_group_segment_fixed_size 0
  .amdhsa_kernarg_size 136
  .amdhsa_user_sgpr_count 2
  .amdhsa_user_sgpr_kernarg_segment_ptr 1
  .amdhsa_system_sgpr_workgroup_id_x 1
.end_amdhsa_kernel
```
